```python
import torch

def _softmax(x, axis=-1):
    return torch.softmax(x, dim=axis)
def _gelu(x):
    return torch.nn.functional.gelu(x, approximate="tanh")
def _silu(x):
    return torch.nn.functional.silu(x)
def _sigmoid(x):
    return torch.sigmoid(x)
def _layernorm(x, axis=-1, eps=1e-5):
    m = x.mean(dim=axis, keepdim=True)
    v = x.var(dim=axis, keepdim=True, unbiased=False)
    return (x - m) / torch.sqrt(v + eps)
def _scatter_add(tgt, idx, src, axis=0):
    return tgt.clone().index_add_(axis, idx, src)
def _segment_sum(src, seg, n):
    out = torch.zeros((n,) + src.shape[1:], dtype=src.dtype)
    return out.index_add_(0, seg, src)
def _pad(x, pw):
    flat = tuple(v for pair in reversed(pw) for v in pair)
    return torch.nn.functional.pad(x, flat)

kernel_name = 'gated_mix__linear_kernel_hedgehog__glu_gated_bilinear__prompt'

def setup_inputs():

    _w = (lambda a: (lambda t: t.to(torch.bfloat16) if t.is_floating_point() else t)(torch.as_tensor(a)))
    def _A_setup():
        B, S, D, H = 1, 2048, 512, 32
        Dh = D // H
        return {
            "x": _w((lambda *s: torch.randn(*s, dtype=torch.bfloat16) * 0.05)(B, S, D)),
            "wqkv": _w((lambda *s: torch.randn(*s, dtype=torch.bfloat16) * 0.8)(D, 3 * D)),
            "w_phi": _w((lambda *s: torch.randn(*s, dtype=torch.bfloat16) * 0.8)(H, Dh, Dh) * (Dh ** -0.5)),
            "wo": _w((lambda *s: torch.randn(*s, dtype=torch.bfloat16) * 0.05)(D, D)),
        }
    _A_in = _A_setup()

    def _B_setup():
        B, S, D, F = 1, 2048, 512, 1376
        return {
            "x": _w((lambda *s: torch.randn(*s, dtype=torch.bfloat16) * 0.05)(B, S, D)),
            "w_gate": _w((lambda *s: torch.randn(*s, dtype=torch.bfloat16) * 1.6)(D, F) * (D ** -0.5)),
            "w_up": _w((lambda *s: torch.randn(*s, dtype=torch.bfloat16) * 1.6)(D, F) * (D ** -0.5)),
            "w_down": _w((lambda *s: torch.randn(*s, dtype=torch.bfloat16) * 1.6)(F, D) * (F ** -0.5)),
        }
    _B_in = _B_setup()

    return {
        "A_x": _A_in["x"],
        "A_wqkv": _A_in["wqkv"],
        "A_w_phi": _A_in["w_phi"],
        "A_wo": _A_in["wo"],
        "B_x": _B_in["x"],
        "B_w_gate": _B_in["w_gate"],
        "B_w_up": _B_in["w_up"],
        "B_w_down": _B_in["w_down"],
        "gate_w": _w((lambda *s: torch.randn(*s, dtype=torch.bfloat16) * 0.05)(512) * 16.0),
    }

def reference(A_x, A_wqkv, A_w_phi, A_wo, B_x, B_w_gate, B_w_up, B_w_down, gate_w):
    def _A_ref(x, wqkv, w_phi, wo):
        B, S, D = x.shape
        H = 32; Dh = D // H
        qkv = (lambda x, *d: x.permute(*d))((x @ wqkv).reshape(B, S, 3, H, Dh), 2, 0, 3, 1, 4)
        q, k, v = qkv[0], qkv[1], qkv[2]
        pq = torch.einsum("bhsd,hdf->bhsf", q, w_phi)
        pk = torch.einsum("bhsd,hdf->bhsf", k, w_phi)
        phi_q = torch.concatenate([_softmax(pq, axis=-1), _softmax(-pq, axis=-1)], axis=-1)
        phi_k = torch.concatenate([_softmax(pk, axis=-1), _softmax(-pk, axis=-1)], axis=-1)
        kv = torch.einsum("bhsf,bhsd->bhfd", phi_k, v)
        z  = torch.einsum("bhsf->bhf", phi_k)
        num = torch.einsum("bhqf,bhfd->bhqd", phi_q, kv)
        den = torch.einsum("bhqf,bhf->bhq", phi_q, z)[..., None] + 1e-6
        o = num / den
        return (lambda x, *d: x.permute(*d))(o, 0, 2, 1, 3).reshape(B, S, D) @ wo

    def _B_ref(x, w_gate, w_up, w_down):
        g = torch.einsum("bsd,df->bsf", x, w_gate)
        u = torch.einsum("bsd,df->bsf", x, w_up)
        h = g * u
        return torch.einsum("bsf,fd->bsd", h, w_down)

    x = A_x
    g = _sigmoid((x * gate_w).sum(-1, keepdims=True))
    a = _A_ref(x, A_wqkv, A_w_phi, A_wo)
    b = _B_ref(x, B_w_gate, B_w_up, B_w_down)
    return g * a + (1 - g) * b
```

```asm
; @launch grid=(256,1,1) block=(512,1,1) lds=163840
.amdgcn_target "amdgcn-amd-amdhsa--gfx950"
.text
.globl gated_mix__linear_kernel_hedgehog__glu_gated_bilinear__prompt_kernel
.p2align 8
.type gated_mix__linear_kernel_hedgehog__glu_gated_bilinear__prompt_kernel,@function
gated_mix__linear_kernel_hedgehog__glu_gated_bilinear__prompt_kernel:
    s_getpc_b64 s[4:5]
    v_and_b32 v1, 127, v0
    v_lshlrev_b32 v1, 7, v1
    v_mov_b32 v121, s5
    v_add_co_u32 v120, vcc, s4, v1
    s_load_dwordx2 s[8:9], s[0:1], 0
    s_load_dwordx2 s[12:13], s[0:1], 8
    v_addc_co_u32 v121, vcc, 0, v121, vcc
    global_load_dword v124, v[120:121], off
    s_cmp_ge_u32 s2, 256
    s_cbranch_scc1 L_end
    v_cmp_gt_u32 vcc, 64, v0
    s_load_dwordx2 s[16:17], s[0:1], 40
    s_load_dwordx2 s[48:49], s[0:1], 48
    s_load_dwordx2 s[44:45], s[0:1], 64
    s_load_dwordx2 s[28:29], s[0:1], 88
    s_load_dwordx2 s[40:41], s[0:1], 16
    s_load_dwordx2 s[24:25], s[0:1], 24
    s_load_dwordx2 s[20:21], s[0:1], 56
    s_load_dwordx2 s[32:33], s[0:1], 72
    v_lshrrev_b32 v1, 6, v0
    v_and_b32 v255, 63, v0
    v_readfirstlane_b32 s64, v1
    s_bfe_u32 s4, s2, 0x30003
    s_lshr_b32 s5, s2, 6
    s_and_b32 s67, s2, 1
    s_lshl_b32 s67, s67, 3
    s_add_u32 s67, s67, s4
    s_lshl_b32 s93, s5, 1
    s_add_u32 s93, s93, s4
    s_bfe_u32 s95, s2, 0x20001
    s_add_u32 s93, s93, s95
    s_and_b32 s93, s93, 7
    s_mov_b32 s10, 2097152
    s_mov_b32 s11, 0x20000
    v_lshrrev_b32 v221, 3, v255
    v_and_b32 v222, 7, v255
    v_lshrrev_b32 v223, 4, v255
    v_xor_b32 v4, v222, v223
    v_lshlrev_b32 v4, 4, v4
    s_lshl_b32 s6, s67, 7
    s_lshl_b32 s7, s64, 4
    s_add_u32 s6, s6, s7
    v_add_u32 v5, s6, v221
    v_lshl_add_u32 v224, v5, 10, v4
    v_xor_b32 v225, 64, v224
    v_add_u32 v225, 7168, v225
    s_lshl_b32 s81, s93, 7
    s_and_b32 s69, s5, 1
    s_sub_u32 s6, 12, s69
    s_lshl_b32 s74, s64, s6
    s_mov_b32 m0, s74
    s_lshl_b32 s68, s95, 1
    s_lshr_b32 s95, s5, 1
    s_add_u32 s68, s68, s95
    s_and_b32 s65, s64, 3
    s_lshr_b32 s66, s64, 2
    v_lshlrev_b32 v188, 4, v255
    s_waitcnt lgkmcnt(0)
    buffer_load_dwordx4 v224, s[8:11], s81 offen offset:0 lds
    buffer_load_dwordx4 v225, s[8:11], s81 offen offset:1024 lds
    s_cmp_eq_u32 s69, 0
    s_cbranch_scc1 L_typeA
    s_mul_i32 s94, s68, 6
    s_mul_i32 s75, s66, 12320
    s_mul_i32 s6, s65, 3072
    s_add_u32 s75, s75, s6
    s_add_u32 s75, s75, 16384
    s_mov_b32 s18, 1409024
    s_mov_b32 s19, 0x20000
    s_cmp_eq_u32 s66, 0
    s_cselect_b32 s16, s16, s48
    s_cselect_b32 s17, s17, s49
    s_mul_i32 s82, s93, 176128
    s_mul_i32 s4, s65, 44032
    s_lshl_b32 s5, s94, 5
    s_add_u32 s4, s4, s5
    v_mul_u32_u24 v191, 5462, v255
    v_lshrrev_b32 v191, 16, v191
    v_mul_u32_u24 v191, 2560, v191
    v_add3_u32 v227, v191, v188, s4
    s_add_u32 m0, s75, 0
    s_nop 0
    buffer_load_dwordx4 v227, s[16:19], s82 offen offset:0 lds
    v_add_u32 v191, 64, v255
    v_mul_u32_u24 v191, 5462, v191
    v_lshrrev_b32 v191, 16, v191
    v_mul_u32_u24 v191, 2560, v191
    v_add3_u32 v228, v191, v188, s4
    v_add_u32 v191, 128, v255
    v_mul_u32_u24 v191, 5462, v191
    v_lshrrev_b32 v191, 16, v191
    v_mul_u32_u24 v191, 2560, v191
    v_add3_u32 v229, v191, v188, s4
    s_mov_b32 s46, 1024
    s_mov_b32 s47, 0x20000
    s_lshl_b32 s6, s67, 4
    s_lshl_b32 s7, s68, 1
    s_add_u32 s6, s6, s7
    s_add_u32 s6, s6, s69
    s_lshl_b32 s6, s6, 3
    s_add_u32 s89, s6, s64
    s_lshl_b32 s88, s89, 10
    s_sub_u32 s12, s12, 4096
    s_subb_u32 s13, s13, 0
    s_mov_b32 s14, 1576960
    s_mov_b32 s15, 0x20000
    s_mov_b32 s30, 16777216
    s_mov_b32 s31, 0x20000
    s_mov_b32 s42, 16384
    s_mov_b32 s43, 0x20000
    s_mov_b32 s26, 524288
    s_mov_b32 s27, 0x20000
    s_mov_b32 s22, 1409024
    s_mov_b32 s23, 0x20000
    s_mov_b32 s34, 2097152
    s_mov_b32 s35, 0x20000
    v_lshrrev_b32 v240, 5, v255
    v_bfe_u32 v241, v255, 4, 1
    v_bfe_u32 v242, v255, 2, 2
    v_and_b32 v243, 3, v255
    v_and_b32 v244, 31, v255
    v_lshrrev_b32 v245, 1, v242
    buffer_load_dwordx4 v228, s[16:19], s82 offen offset:1024 lds
    v_and_b32 v246, 1, v243
    v_lshrrev_b32 v247, 1, v243
    v_bfe_u32 v191, v244, 1, 3
    v_xor_b32 v191, v191, v240
    v_lshlrev_b32 v191, 4, v191
    v_lshl_add_u32 v191, v244, 7, v191
    s_lshl_b32 s6, s65, 12
    v_add_u32 v231, s6, v191
    v_xor_b32 v232, 32, v231
    v_xor_b32 v233, 64, v231
    v_xor_b32 v234, 96, v231
    v_add_u32 v216, 81984, v231
    v_add_u32 v217, 81984, v232
    v_add_u32 v218, 81984, v233
    v_add_u32 v219, 81984, v234
    v_lshlrev_b32 v249, 2, v255
    v_mov_b32 v18, 0
    buffer_load_dwordx4 v229, s[16:19], s82 offen offset:2048 lds
    v_mov_b32 v19, 0
    v_mov_b32 v190, 162560
    v_lshl_add_u32 v251, v255, 3, v190
    ds_write_b64 v251, v[18:19]
    s_add_u32 s6, s2, s64
    s_and_b32 s6, s6, 7
    s_lshl_b32 s6, s6, 5
    s_lshr_b32 s7, s2, 3
    s_add_u32 s6, s6, s7
    s_sub_u32 s7, s6, 172
    s_cmp_lt_u32 s6, 172
    s_cselect_b32 s6, s6, s7
    s_cselect_b32 s36, s20, s24
    s_cselect_b32 s37, s21, s25
    s_cselect_b32 s38, s22, s26
    s_mov_b32 s39, 0x20000
    s_lshl_b32 s91, s6, 13
    buffer_load_dwordx4 v[24:27], v188, s[8:11], s88 offen
    buffer_load_dwordx4 v[28:31], v188, s[44:47], 0 offen
    v_lshlrev_b32 v252, 7, v255
    v_lshl_add_u32 v191, v240, 3, v242
    v_mul_u32_u24 v191, 192, v191
    v_mul_u32_u24 v251, 12320, v241
    v_lshl_add_u32 v251, v243, 3, v251
    s_mul_i32 s6, s66, 96
    s_add_u32 s6, s6, 16384
    v_add3_u32 v230, v191, v251, s6
    v_add_u32 v220, 81984, v230
    buffer_load_dword v248, off, s[28:31], 0 sc1
    s_cmp_ge_u32 s64, 2
    s_cbranch_scc1 L_wp_1
    s_lshl_b32 s7, s64, 10
    s_add_u32 m0, s7, 156160
    s_lshl_b32 s6, s68, 11
    s_add_u32 s6, s6, s7
    buffer_load_dwordx4 v188, s[40:43], s6 offen lds
L_wp_1:
    s_mul_i32 s56, s93, 196608
    s_add_u32 s56, s56, 4096
    s_add_u32 s93, s93, 1
    s_and_b32 s93, s93, 7
    s_lshl_b32 s41, s93, 7
    s_mul_i32 s49, s93, 176128
    s_mul_i32 s57, s93, 196608
    s_add_u32 s57, s57, 3072
    s_add_u32 s93, s93, 1
    s_and_b32 s93, s93, 7
    s_lshl_b32 s42, s93, 7
    s_mul_i32 s50, s93, 176128
    s_mul_i32 s58, s93, 196608
    s_add_u32 s58, s58, 2048
    s_add_u32 s93, s93, 1
    s_and_b32 s93, s93, 7
    s_lshl_b32 s43, s93, 7
    s_mul_i32 s51, s93, 176128
    s_mul_i32 s59, s93, 196608
    s_add_u32 s59, s59, 1024
    s_add_u32 s93, s93, 1
    s_and_b32 s93, s93, 7
    s_lshl_b32 s44, s93, 7
    s_mul_i32 s52, s93, 176128
    s_mul_i32 s60, s93, 196608
    s_add_u32 s60, s60, 4096
    s_add_u32 s93, s93, 1
    s_and_b32 s93, s93, 7
    s_lshl_b32 s45, s93, 7
    s_mul_i32 s53, s93, 176128
    s_mul_i32 s61, s93, 196608
    s_add_u32 s61, s61, 3072
    s_add_u32 s93, s93, 1
    s_and_b32 s93, s93, 7
    s_lshl_b32 s46, s93, 7
    s_mul_i32 s54, s93, 176128
    s_mul_i32 s62, s93, 196608
    s_add_u32 s62, s62, 2048
    s_add_u32 s93, s93, 1
    s_and_b32 s93, s93, 7
    s_lshl_b32 s47, s93, 7
    s_mul_i32 s55, s93, 176128
    s_mul_i32 s63, s93, 196608
    s_add_u32 s63, s63, 1024
    s_add_u32 m0, s74, 40992
    s_nop 0
    buffer_load_dwordx4 v224, s[8:11], s41 offen offset:0 lds
    buffer_load_dwordx4 v225, s[8:11], s41 offen offset:1024 lds
    s_add_u32 m0, s75, 40992
    s_nop 0
    buffer_load_dwordx4 v227, s[16:19], s49 offen offset:0 lds
    buffer_load_dwordx4 v228, s[16:19], s49 offen offset:1024 lds
    buffer_load_dwordx4 v229, s[16:19], s49 offen offset:2048 lds
    s_branch L_typeB
L_typeA:
    v_and_b32 v191, 1, v223
    v_lshlrev_b32 v189, 2, v191
    v_xor_b32 v189, v222, v189
    v_lshlrev_b32 v189, 4, v189
    s_lshl_b32 s4, s64, 3
    v_add_u32 v191, s4, v221
    v_mul_u32_u24 v191, 3072, v191
    s_lshl_b32 s4, s68, 7
    s_add_u32 s4, s4, 3072
    v_add3_u32 v226, v191, v189, s4
    s_sub_u32 s12, s12, 4096
    s_subb_u32 s13, s13, 0
    s_mov_b32 s14, 1576960
    s_mov_b32 s15, 0x20000
    s_mul_i32 s82, s93, 196608
    buffer_load_dwordx4 v226, s[12:15], s82 offen offset:2048 lds
    buffer_load_dwordx4 v226, s[12:15], s82 offen offset:3072 lds
    s_mov_b32 s46, 1024
    s_mov_b32 s47, 0x20000
    s_lshl_b32 s6, s67, 4
    s_lshl_b32 s7, s68, 1
    s_add_u32 s6, s6, s7
    s_add_u32 s6, s6, s69
    s_lshl_b32 s6, s6, 3
    s_add_u32 s89, s6, s64
    s_lshl_b32 s88, s89, 10
    s_mov_b32 s18, 1409024
    s_mov_b32 s19, 0x20000
    s_cmp_eq_u32 s66, 0
    s_cselect_b32 s16, s16, s48
    s_cselect_b32 s17, s17, s49
    s_mov_b32 s30, 16777216
    s_mov_b32 s31, 0x20000
    s_mov_b32 s42, 16384
    s_mov_b32 s43, 0x20000
    s_mov_b32 s26, 524288
    s_mov_b32 s27, 0x20000
    s_mov_b32 s22, 1409024
    s_mov_b32 s23, 0x20000
    s_mov_b32 s34, 2097152
    s_mov_b32 s35, 0x20000
    v_lshrrev_b32 v240, 5, v255
    v_bfe_u32 v241, v255, 4, 1
    v_bfe_u32 v242, v255, 2, 2
    v_and_b32 v243, 3, v255
    v_and_b32 v244, 31, v255
    v_lshrrev_b32 v245, 1, v242
    v_and_b32 v246, 1, v243
    v_lshrrev_b32 v247, 1, v243
    v_bfe_u32 v191, v244, 1, 3
    v_xor_b32 v191, v191, v240
    v_lshlrev_b32 v191, 4, v191
    v_and_b32 v251, 15, v244
    v_lshl_add_u32 v191, v251, 7, v191
    v_lshl_add_u32 v191, v241, 12, v191
    s_lshl_b32 s6, s65, 13
    v_add_u32 v231, s6, v191
    v_xor_b32 v232, 32, v231
    v_xor_b32 v233, 64, v231
    v_xor_b32 v234, 96, v231
    v_add_u32 v216, 65536, v231
    v_add_u32 v217, 65536, v232
    v_add_u32 v218, 65536, v233
    v_add_u32 v219, 65536, v234
    v_lshlrev_b32 v249, 2, v255
    v_mov_b32 v18, 0
    buffer_load_dwordx4 v[24:27], v188, s[8:11], s88 offen
    buffer_load_dwordx4 v[28:31], v188, s[44:47], 0 offen
    v_mov_b32 v19, 0
    v_mov_b32 v190, 162560
    v_lshl_add_u32 v251, v255, 3, v190
    ds_write_b64 v251, v[18:19]
    s_add_u32 s6, s2, s64
    s_and_b32 s6, s6, 7
    s_lshl_b32 s6, s6, 5
    s_lshr_b32 s7, s2, 3
    s_add_u32 s6, s6, s7
    s_sub_u32 s7, s6, 172
    s_cmp_lt_u32 s6, 172
    s_cselect_b32 s6, s6, s7
    s_cselect_b32 s36, s20, s24
    s_cselect_b32 s37, s21, s25
    s_cselect_b32 s38, s22, s26
    s_mov_b32 s39, 0x20000
    s_lshl_b32 s91, s6, 13
    v_lshlrev_b32 v252, 7, v255
    v_xor_b32 v251, s66, v245
    v_lshlrev_b32 v251, 6, v251
    v_lshl_add_u32 v251, v242, 7, v251
    v_lshl_add_u32 v251, v240, 12, v251
    v_lshl_add_u32 v251, v246, 5, v251
    v_lshl_add_u32 v251, v241, 4, v251
    v_lshl_add_u32 v235, v247, 3, v251
    v_add_u32 v235, 2048, v235
    v_add_u32 v220, 65536, v235
    buffer_load_dword v248, off, s[28:31], 0 sc1
    s_cmp_ge_u32 s64, 2
    s_cbranch_scc1 L_wp_2
    s_lshl_b32 s7, s64, 10
    s_add_u32 m0, s7, 156160
    s_lshl_b32 s6, s68, 11
    s_add_u32 s6, s6, s7
    buffer_load_dwordx4 v188, s[40:43], s6 offen lds
L_wp_2:
    s_mul_i32 s56, s93, 176128
    s_add_u32 s93, s93, 1
    s_and_b32 s93, s93, 7
    s_lshl_b32 s41, s93, 7
    s_mul_i32 s49, s93, 196608
    s_mul_i32 s57, s93, 176128
    s_add_u32 s93, s93, 1
    s_and_b32 s93, s93, 7
    s_lshl_b32 s42, s93, 7
    s_mul_i32 s50, s93, 196608
    s_mul_i32 s58, s93, 176128
    s_add_u32 s93, s93, 1
    s_and_b32 s93, s93, 7
    s_lshl_b32 s43, s93, 7
    s_mul_i32 s51, s93, 196608
    s_mul_i32 s59, s93, 176128
    s_add_u32 s93, s93, 1
    s_and_b32 s93, s93, 7
    s_lshl_b32 s44, s93, 7
    s_mul_i32 s52, s93, 196608
    s_mul_i32 s60, s93, 176128
    s_add_u32 s93, s93, 1
    s_and_b32 s93, s93, 7
    s_lshl_b32 s45, s93, 7
    s_mul_i32 s53, s93, 196608
    s_mul_i32 s61, s93, 176128
    s_add_u32 s93, s93, 1
    s_and_b32 s93, s93, 7
    s_lshl_b32 s46, s93, 7
    s_mul_i32 s54, s93, 196608
    s_mul_i32 s62, s93, 176128
    s_add_u32 s93, s93, 1
    s_and_b32 s93, s93, 7
    s_lshl_b32 s47, s93, 7
    s_mul_i32 s55, s93, 196608
    s_mul_i32 s63, s93, 176128
    s_add_u32 m0, s74, 32768
    s_nop 0
    buffer_load_dwordx4 v224, s[8:11], s41 offen offset:0 lds
    buffer_load_dwordx4 v225, s[8:11], s41 offen offset:1024 lds
    buffer_load_dwordx4 v226, s[12:15], s49 offen offset:2048 lds
    buffer_load_dwordx4 v226, s[12:15], s49 offen offset:3072 lds
    s_mul_i32 s94, s68, 5
    s_add_u32 s94, s94, 48
    s_min_u32 s94, s94, 82
    s_mul_i32 s75, s66, 10368
    s_and_b32 s6, s65, 2
    s_mul_i32 s6, s6, 2560
    s_add_u32 s75, s75, s6
    s_and_b32 s6, s65, 1
    s_mul_i32 s6, s6, 3072
    s_add_u32 s75, s75, s6
    s_and_b32 s4, s65, 2
    s_mul_i32 s4, s4, 44032
    s_and_b32 s7, s65, 1
    s_mul_i32 s7, s7, 192
    s_lshl_b32 s5, s7, 4
    s_add_u32 s4, s4, s5
    s_lshl_b32 s5, s94, 5
    s_add_u32 s4, s4, s5
    v_add_u32 v191, s7, v255
    s_add_u32 s7, s7, 64
    v_mul_u32_u24 v191, 6554, v191
    v_lshrrev_b32 v191, 16, v191
    v_mul_u32_u24 v191, 2592, v191
    v_add3_u32 v227, v191, v188, s4
    v_add_u32 v191, s7, v255
    s_add_u32 s7, s7, 64
    v_mul_u32_u24 v191, 6554, v191
    v_lshrrev_b32 v191, 16, v191
    v_mul_u32_u24 v191, 2592, v191
    v_add3_u32 v228, v191, v188, s4
    v_add_u32 v191, s7, v255
    v_mul_u32_u24 v191, 6554, v191
    v_lshrrev_b32 v191, 16, v191
    v_mul_u32_u24 v191, 2592, v191
    v_add3_u32 v229, v191, v188, s4
    s_mul_i32 s6, s66, 3
    s_add_u32 s94, s94, s6
    v_lshl_add_u32 v191, v240, 3, v242
    v_mul_u32_u24 v191, 160, v191
    v_mul_u32_u24 v251, 10368, v241
    v_lshl_add_u32 v251, v243, 3, v251
    s_mul_i32 s6, s66, 96
    s_add_u32 s6, s6, 65536
    v_add3_u32 v230, v191, v251, s6
    s_lshr_b32 s7, s2, 3
    s_and_b32 s6, s2, 7
    s_and_b32 s70, s7, 3
    s_lshl_b32 s6, s6, 2
    s_add_u32 s70, s70, s6
    s_lshr_b32 s71, s7, 2
    v_lshl_add_u32 v251, v240, 2, v242
    s_lshl_b32 s77, s65, 11
    v_lshl_add_u32 v251, v251, 7, s77
    v_lshl_add_u32 v251, v245, 6, v251
    v_lshl_add_u32 v251, v241, 5, v251
    v_lshl_add_u32 v236, v243, 3, v251
    v_xor_b32 v237, 64, v236
    s_lshl_b32 s6, s66, 13
    s_lshl_b32 s7, s71, 7
    s_add_u32 s6, s6, s7
    v_lshl_add_u32 v191, v221, 10, v189
    v_add_u32 v238, s6, v191
    s_lshl_b32 s6, s66, 10
    s_add_u32 s77, s77, s6
    s_mul_i32 s78, s65, 196608
    s_mul_i32 s79, s65, 163840
    s_add_u32 s79, s79, 786432
    s_lshl_b32 s80, s65, 17
    s_lshr_b32 s81, s78, 4
    s_lshr_b32 s82, s79, 4
    s_lshr_b32 s83, s80, 4
    s_add_u32 s83, s83, 90112
    s_lshl_b32 s6, s67, 2
    s_add_u32 s6, s6, s65
    s_mul_i32 s6, s6, 122880
    s_lshl_b32 s7, s94, 10
    s_add_u32 s6, s6, s7
    s_add_u32 s6, s6, 2097152
    v_add_u32 v239, s6, v188
    s_lshl_b32 s6, s70, 1
    s_add_u32 s6, s6, s66
    s_mul_i32 s6, s6, 122880
    s_add_u32 s6, s6, 2097152
    v_add_u32 v253, s6, v188
    s_lshl_b32 s6, s67, 3
    s_add_u32 s6, s6, s68
    s_lshl_b32 s6, s6, 8
    s_add_u32 s85, s6, 786432
    s_lshl_b32 s84, s68, 4
    s_add_u32 s84, s84, s67
    s_lshl_b32 s84, s84, 8
    s_add_u32 s84, s84, 720896
    s_lshr_b32 s86, s70, 1
    s_lshl_b32 s86, s86, 11
    s_add_u32 s86, s86, 753664
    s_cmp_eq_u32 s64, 0
    s_cselect_b32 s84, s84, 2147483648
    s_cselect_b32 s85, s85, 2147483648
    s_cselect_b32 s86, s86, 2147483648
    v_lshlrev_b32 v250, 8, v222
    v_cmp_eq_u32 vcc, v246, v240
    s_lshl_b32 s6, s66, 10
    s_add_u32 s6, s6, 156160
    v_lshl_add_u32 v251, v240, 9, s6
    v_lshl_add_u32 v251, v242, 5, v251
    v_lshl_add_u32 v251, v241, 4, v251
    v_lshl_add_u32 v251, v247, 3, v251
    v_cndmask_b32 v170, v190, v251, vcc
    s_lshl_b32 s6, s66, 8
    s_lshl_b32 s7, s65, 5
    s_add_u32 s6, s6, s7
    v_lshl_add_u32 v191, v240, 7, v244
    v_add_u32 v191, s6, v191
    s_mov_b32 s6, 139520
    v_lshl_add_u32 v160, v191, 5, s6
    v_bfe_u32 v251, v255, 1, 2
    v_lshlrev_b32 v251, 4, v251
    v_lshl_add_u32 v161, v191, 6, v251
    v_xor_b32 v162, 16, v161
    v_xor_b32 v163, 32, v161
    v_xor_b32 v164, 48, v161
    v_lshl_add_u32 v191, v223, 3, v242
    s_lshl_b32 s6, s66, 1
    v_or_b32 v251, s6, v247
    v_xor_b32 v251, v251, v245
    v_lshlrev_b32 v251, 4, v251
    v_lshl_add_u32 v251, v246, 3, v251
    v_lshl_add_u32 v251, v191, 6, v251
    s_lshl_b32 s6, s65, 13
    v_add_u32 v165, s6, v251
    v_xor_b32 v166, 32, v165
    s_lshl_b32 s6, s65, 12
    s_add_u32 s6, s6, 139520
    v_lshl_add_u32 v191, v191, 5, s6
    v_lshl_add_u32 v167, v243, 3, v191
    v_lshlrev_b32 v168, 3, v255
    v_lshlrev_b32 v191, 3, v223
    v_lshl_add_u32 v169, v243, 5, v191
    v_mov_b32 v172, 0x3f803f80
    v_mov_b32 v173, 0x3f803f80
    v_mov_b32 v174, 0x3f803f80
    v_mov_b32 v175, 0x3f803f80
    s_lshl_b32 s88, s68, 4
    s_add_u32 s88, s88, s67
    s_mul_i32 s88, s88, 5120
    s_mul_i32 s6, s64, 640
    s_add_u32 s88, s88, s6
    s_add_u32 s88, s88, 65536
    s_mov_b32 s90, 1024
    s_cmp_eq_u32 s68, 6
    s_cselect_b32 s90, 5120, s90
    s_cmp_eq_u32 s68, 7
    s_cselect_b32 s90, 2048, s90
    v_mov_b32 v32, 0
    s_waitcnt vmcnt(5)
    v_dot2c_f32_bf16 v32, v24, v28
    v_dot2c_f32_bf16 v32, v25, v29
    v_dot2c_f32_bf16 v32, v26, v30
    v_dot2c_f32_bf16 v32, v27, v31
    s_lshl_b32 s6, s64, 2
    s_add_u32 s6, s6, 163328
    v_mov_b32 v33, s6
    s_nop 2
    v_add_f32 v32, v32, v32 row_shr:1 bound_ctrl:0
    s_nop 1
    v_add_f32 v32, v32, v32 row_shr:2 bound_ctrl:0
    s_nop 1
    v_add_f32 v32, v32, v32 row_shr:4 bound_ctrl:0
    s_nop 1
    v_add_f32 v32, v32, v32 row_shr:8 bound_ctrl:0
    s_nop 1
    v_add_f32 v32, v32, v32 row_bcast:15 row_mask:0xa
    s_nop 1
    v_add_f32 v32, v32, v32 row_bcast:31 row_mask:0xc
    s_nop 0
    v_readlane_b32 s7, v32, 63
    v_mov_b32 v32, 0xbfb8aa3b
    s_nop 0
    v_mul_f32 v32, s7, v32
    v_exp_f32 v32, v32
    s_nop 0
    v_add_f32 v32, 1.0, v32
    v_rcp_f32 v32, v32
    s_mov_b64 exec, 1
    ds_write_b32 v33, v32
    s_mov_b64 exec, -1
    s_waitcnt lgkmcnt(0)
    s_barrier
    ds_read_b128 v[0:3], v231 offset:0
    ds_read_b64_tr_b16 v[192:193], v235 offset:0
    ds_read_b64_tr_b16 v[194:195], v235 offset:512
    ds_read_b64_tr_b16 v[196:197], v235 offset:1024
    ds_read_b64_tr_b16 v[198:199], v235 offset:1536
    s_waitcnt lgkmcnt(2)
    v_mfma_f32_32x32x16_bf16 v[128:143], v[192:195], v[0:3], 0
    ds_read_b128 v[4:7], v232 offset:0
    ds_read_b64_tr_b16 v[200:201], v235 offset:8192
    ds_read_b64_tr_b16 v[202:203], v235 offset:8704
    s_add_u32 m0, s74, 65536
    s_nop 0
    buffer_load_dwordx4 v224, s[8:11], s42 offen offset:0 lds
    s_waitcnt lgkmcnt(3)
    v_mfma_f32_32x32x16_bf16 v[144:159], v[196:199], v[0:3], 0
    ds_read_b64_tr_b16 v[204:205], v235 offset:9216
    ds_read_b64_tr_b16 v[206:207], v235 offset:9728
    s_waitcnt lgkmcnt(2)
    v_mfma_f32_32x32x16_bf16 v[128:143], v[200:203], v[4:7], v[128:143]
    ds_read_b128 v[8:11], v233 offset:0
    ds_read_b64_tr_b16 v[192:193], v235 offset:16384
    ds_read_b64_tr_b16 v[194:195], v235 offset:16896
    buffer_load_dwordx4 v225, s[8:11], s42 offen offset:1024 lds
    s_waitcnt lgkmcnt(3)
    v_mfma_f32_32x32x16_bf16 v[144:159], v[204:207], v[4:7], v[144:159]
    ds_read_b64_tr_b16 v[196:197], v235 offset:17408
    ds_read_b64_tr_b16 v[198:199], v235 offset:17920
    buffer_load_dwordx4 v226, s[12:15], s50 offen offset:2048 lds
    s_waitcnt lgkmcnt(2)
    v_mfma_f32_32x32x16_bf16 v[128:143], v[192:195], v[8:11], v[128:143]
    ds_read_b128 v[12:15], v234 offset:0
    ds_read_b64_tr_b16 v[200:201], v235 offset:24576
    ds_read_b64_tr_b16 v[202:203], v235 offset:25088
    ds_read_b64_tr_b16 v[204:205], v235 offset:25600
    ds_read_b64_tr_b16 v[206:207], v235 offset:26112
    s_waitcnt lgkmcnt(5)
    v_mfma_f32_32x32x16_bf16 v[144:159], v[196:199], v[8:11], v[144:159]
    buffer_load_dwordx4 v226, s[12:15], s50 offen offset:3072 lds
    s_waitcnt vmcnt(4) lgkmcnt(0)
    s_barrier
    v_mfma_f32_32x32x16_bf16 v[128:143], v[200:203], v[12:15], v[128:143]
    ds_read_b128 v[16:19], v231 offset:32768
    ds_read_b64_tr_b16 v[192:193], v235 offset:32768
    ds_read_b64_tr_b16 v[194:195], v235 offset:33280
    s_add_u32 m0, s74, 0
    s_nop 0
    buffer_load_dwordx4 v224, s[8:11], s43 offen offset:0 lds
    v_mfma_f32_32x32x16_bf16 v[144:159], v[204:207], v[12:15], v[144:159]
    ds_read_b64_tr_b16 v[196:197], v235 offset:33792
    ds_read_b64_tr_b16 v[198:199], v235 offset:34304
    s_waitcnt lgkmcnt(2)
    v_mfma_f32_32x32x16_bf16 v[128:143], v[192:195], v[16:19], v[128:143]
    ds_read_b128 v[20:23], v232 offset:32768
    ds_read_b64_tr_b16 v[200:201], v235 offset:40960
    ds_read_b64_tr_b16 v[202:203], v235 offset:41472
    buffer_load_dwordx4 v225, s[8:11], s43 offen offset:1024 lds
    s_waitcnt lgkmcnt(3)
    v_mfma_f32_32x32x16_bf16 v[144:159], v[196:199], v[16:19], v[144:159]
    ds_read_b64_tr_b16 v[204:205], v235 offset:41984
    ds_read_b64_tr_b16 v[206:207], v235 offset:42496
    s_waitcnt lgkmcnt(2)
    v_mfma_f32_32x32x16_bf16 v[128:143], v[200:203], v[20:23], v[128:143]
    ds_read_b128 v[24:27], v233 offset:32768
    ds_read_b64_tr_b16 v[192:193], v235 offset:49152
    ds_read_b64_tr_b16 v[194:195], v235 offset:49664
    buffer_load_dwordx4 v226, s[12:15], s51 offen offset:2048 lds
    s_waitcnt lgkmcnt(3)
    v_mfma_f32_32x32x16_bf16 v[144:159], v[204:207], v[20:23], v[144:159]
    ds_read_b64_tr_b16 v[196:197], v235 offset:50176
    ds_read_b64_tr_b16 v[198:199], v235 offset:50688
    s_waitcnt lgkmcnt(2)
    v_mfma_f32_32x32x16_bf16 v[128:143], v[192:195], v[24:27], v[128:143]
    ds_read_b128 v[28:31], v234 offset:32768
    ds_read_b64_tr_b16 v[200:201], v235 offset:57344
    ds_read_b64_tr_b16 v[202:203], v235 offset:57856
    ds_read_b64_tr_b16 v[204:205], v235 offset:58368
    ds_read_b64_tr_b16 v[206:207], v235 offset:58880
    buffer_load_dwordx4 v226, s[12:15], s51 offen offset:3072 lds
    s_waitcnt lgkmcnt(5)
    v_mfma_f32_32x32x16_bf16 v[144:159], v[196:199], v[24:27], v[144:159]
    s_waitcnt vmcnt(4) lgkmcnt(0)
    s_barrier
    v_mfma_f32_32x32x16_bf16 v[128:143], v[200:203], v[28:31], v[128:143]
    ds_read_b128 v[32:35], v216 offset:0
    ds_read_b64_tr_b16 v[192:193], v220 offset:0
    ds_read_b64_tr_b16 v[194:195], v220 offset:512
    s_add_u32 m0, s74, 32768
    s_nop 0
    buffer_load_dwordx4 v224, s[8:11], s44 offen offset:0 lds
    v_mfma_f32_32x32x16_bf16 v[144:159], v[204:207], v[28:31], v[144:159]
    ds_read_b64_tr_b16 v[196:197], v220 offset:1024
    ds_read_b64_tr_b16 v[198:199], v220 offset:1536
    s_waitcnt lgkmcnt(2)
    v_mfma_f32_32x32x16_bf16 v[128:143], v[192:195], v[32:35], v[128:143]
    ds_read_b128 v[36:39], v217 offset:0
    ds_read_b64_tr_b16 v[200:201], v220 offset:8192
    ds_read_b64_tr_b16 v[202:203], v220 offset:8704
    buffer_load_dwordx4 v225, s[8:11], s44 offen offset:1024 lds
    s_waitcnt lgkmcnt(3)
    v_mfma_f32_32x32x16_bf16 v[144:159], v[196:199], v[32:35], v[144:159]
    ds_read_b64_tr_b16 v[204:205], v220 offset:9216
    ds_read_b64_tr_b16 v[206:207], v220 offset:9728
    buffer_load_dwordx4 v226, s[12:15], s52 offen offset:2048 lds
    s_waitcnt lgkmcnt(2)
    v_mfma_f32_32x32x16_bf16 v[128:143], v[200:203], v[36:39], v[128:143]
    ds_read_b128 v[40:43], v218 offset:0
    ds_read_b64_tr_b16 v[192:193], v220 offset:16384
    ds_read_b64_tr_b16 v[194:195], v220 offset:16896
    s_waitcnt lgkmcnt(3)
    v_mfma_f32_32x32x16_bf16 v[144:159], v[204:207], v[36:39], v[144:159]
    ds_read_b64_tr_b16 v[196:197], v220 offset:17408
    ds_read_b64_tr_b16 v[198:199], v220 offset:17920
    buffer_load_dwordx4 v226, s[12:15], s52 offen offset:3072 lds
    s_waitcnt lgkmcnt(2)
    v_mfma_f32_32x32x16_bf16 v[128:143], v[192:195], v[40:43], v[128:143]
    ds_read_b128 v[44:47], v219 offset:0
    ds_read_b64_tr_b16 v[200:201], v220 offset:24576
    ds_read_b64_tr_b16 v[202:203], v220 offset:25088
    ds_read_b64_tr_b16 v[204:205], v220 offset:25600
    ds_read_b64_tr_b16 v[206:207], v220 offset:26112
    s_waitcnt lgkmcnt(5)
    v_mfma_f32_32x32x16_bf16 v[144:159], v[196:199], v[40:43], v[144:159]
    s_cmp_lg_u32 s64, 1
    s_cbranch_scc1 L_gs_3
    v_and_b32 v126, 28, v249
    v_add_u32 v126, 163328, v126
    ds_read_b32 v127, v126
    s_lshr_b32 s95, s89, 3
    s_lshl_b32 s95, s95, 7
    s_add_u32 s95, s95, 1048576
    s_mov_b32 exec_hi, 0
    s_waitcnt lgkmcnt(0)
    buffer_store_dword v127, v249, s[28:31], s95 offen sc1
    s_mov_b32 exec_hi, -1
L_gs_3:
    s_waitcnt vmcnt(4) lgkmcnt(0)
    s_barrier
    v_readfirstlane_b32 s73, v248
    s_nop 0
    s_mul_i32 s72, s73, 0x9e3779b1
    s_add_u32 s72, s72, 0x7f4a7c15
    v_mov_b32 v248, s72
    v_mfma_f32_32x32x16_bf16 v[128:143], v[200:203], v[44:47], v[128:143]
    ds_read_b128 v[48:51], v231 offset:0
    ds_read_b64_tr_b16 v[192:193], v235 offset:0
    ds_read_b64_tr_b16 v[194:195], v235 offset:512
    s_add_u32 m0, s74, 65536
    s_nop 0
    buffer_load_dwordx4 v224, s[8:11], s45 offen offset:0 lds
    v_mfma_f32_32x32x16_bf16 v[144:159], v[204:207], v[44:47], v[144:159]
    ds_read_b64_tr_b16 v[196:197], v235 offset:1024
    ds_read_b64_tr_b16 v[198:199], v235 offset:1536
    s_waitcnt lgkmcnt(2)
    v_mfma_f32_32x32x16_bf16 v[128:143], v[192:195], v[48:51], v[128:143]
    ds_read_b128 v[52:55], v232 offset:0
    ds_read_b64_tr_b16 v[200:201], v235 offset:8192
    ds_read_b64_tr_b16 v[202:203], v235 offset:8704
    buffer_load_dwordx4 v225, s[8:11], s45 offen offset:1024 lds
    s_waitcnt lgkmcnt(3)
    v_mfma_f32_32x32x16_bf16 v[144:159], v[196:199], v[48:51], v[144:159]
    ds_read_b64_tr_b16 v[204:205], v235 offset:9216
    ds_read_b64_tr_b16 v[206:207], v235 offset:9728
    buffer_load_dwordx4 v226, s[12:15], s53 offen offset:2048 lds
    s_waitcnt lgkmcnt(2)
    v_mfma_f32_32x32x16_bf16 v[128:143], v[200:203], v[52:55], v[128:143]
    ds_read_b128 v[56:59], v233 offset:0
    ds_read_b64_tr_b16 v[192:193], v235 offset:16384
    ds_read_b64_tr_b16 v[194:195], v235 offset:16896
    s_waitcnt lgkmcnt(3)
    v_mfma_f32_32x32x16_bf16 v[144:159], v[204:207], v[52:55], v[144:159]
    ds_read_b64_tr_b16 v[196:197], v235 offset:17408
    ds_read_b64_tr_b16 v[198:199], v235 offset:17920
    buffer_load_dwordx4 v226, s[12:15], s53 offen offset:3072 lds
    s_waitcnt lgkmcnt(2)
    v_mfma_f32_32x32x16_bf16 v[128:143], v[192:195], v[56:59], v[128:143]
    ds_read_b128 v[60:63], v234 offset:0
    ds_read_b64_tr_b16 v[200:201], v235 offset:24576
    ds_read_b64_tr_b16 v[202:203], v235 offset:25088
    ds_read_b64_tr_b16 v[204:205], v235 offset:25600
    ds_read_b64_tr_b16 v[206:207], v235 offset:26112
    s_waitcnt lgkmcnt(5)
    v_mfma_f32_32x32x16_bf16 v[144:159], v[196:199], v[56:59], v[144:159]
    s_cmp_lg_u32 s64, 0
    s_cbranch_scc1 L_tc_4
    s_mov_b32 m0, 163072
    s_nop 0
    buffer_load_dword v252, s[36:39], s91 offen lds
L_tc_4:
    s_waitcnt vmcnt(4) lgkmcnt(0)
    s_barrier
    v_mfma_f32_32x32x16_bf16 v[128:143], v[200:203], v[60:63], v[128:143]
    ds_read_b128 v[64:67], v231 offset:32768
    ds_read_b64_tr_b16 v[192:193], v235 offset:32768
    ds_read_b64_tr_b16 v[194:195], v235 offset:33280
    s_add_u32 m0, s74, 0
    s_nop 0
    buffer_load_dwordx4 v224, s[8:11], s46 offen offset:0 lds
    v_mfma_f32_32x32x16_bf16 v[144:159], v[204:207], v[60:63], v[144:159]
    ds_read_b64_tr_b16 v[196:197], v235 offset:33792
    ds_read_b64_tr_b16 v[198:199], v235 offset:34304
    s_waitcnt lgkmcnt(2)
    v_mfma_f32_32x32x16_bf16 v[128:143], v[192:195], v[64:67], v[128:143]
    ds_read_b128 v[68:71], v232 offset:32768
    ds_read_b64_tr_b16 v[200:201], v235 offset:40960
    ds_read_b64_tr_b16 v[202:203], v235 offset:41472
    buffer_load_dwordx4 v225, s[8:11], s46 offen offset:1024 lds
    s_waitcnt lgkmcnt(3)
    v_mfma_f32_32x32x16_bf16 v[144:159], v[196:199], v[64:67], v[144:159]
    ds_read_b64_tr_b16 v[204:205], v235 offset:41984
    ds_read_b64_tr_b16 v[206:207], v235 offset:42496
    s_waitcnt lgkmcnt(2)
    v_mfma_f32_32x32x16_bf16 v[128:143], v[200:203], v[68:71], v[128:143]
    ds_read_b128 v[72:75], v233 offset:32768
    ds_read_b64_tr_b16 v[192:193], v235 offset:49152
    ds_read_b64_tr_b16 v[194:195], v235 offset:49664
    buffer_load_dwordx4 v226, s[12:15], s54 offen offset:2048 lds
    s_waitcnt lgkmcnt(3)
    v_mfma_f32_32x32x16_bf16 v[144:159], v[204:207], v[68:71], v[144:159]
    ds_read_b64_tr_b16 v[196:197], v235 offset:50176
    ds_read_b64_tr_b16 v[198:199], v235 offset:50688
    s_waitcnt lgkmcnt(2)
    v_mfma_f32_32x32x16_bf16 v[128:143], v[192:195], v[72:75], v[128:143]
    ds_read_b128 v[76:79], v234 offset:32768
    ds_read_b64_tr_b16 v[200:201], v235 offset:57344
    ds_read_b64_tr_b16 v[202:203], v235 offset:57856
    ds_read_b64_tr_b16 v[204:205], v235 offset:58368
    ds_read_b64_tr_b16 v[206:207], v235 offset:58880
    buffer_load_dwordx4 v226, s[12:15], s54 offen offset:3072 lds
    s_waitcnt lgkmcnt(5)
    v_mfma_f32_32x32x16_bf16 v[144:159], v[196:199], v[72:75], v[144:159]
    s_waitcnt vmcnt(4) lgkmcnt(0)
    s_barrier
    v_mfma_f32_32x32x16_bf16 v[128:143], v[200:203], v[76:79], v[128:143]
    ds_read_b128 v[80:83], v216 offset:0
    ds_read_b64_tr_b16 v[192:193], v220 offset:0
    ds_read_b64_tr_b16 v[194:195], v220 offset:512
    s_add_u32 m0, s74, 32768
    s_nop 0
    buffer_load_dwordx4 v224, s[8:11], s47 offen offset:0 lds
    v_mfma_f32_32x32x16_bf16 v[144:159], v[204:207], v[76:79], v[144:159]
    ds_read_b64_tr_b16 v[196:197], v220 offset:1024
    ds_read_b64_tr_b16 v[198:199], v220 offset:1536
    s_waitcnt lgkmcnt(2)
    v_mfma_f32_32x32x16_bf16 v[128:143], v[192:195], v[80:83], v[128:143]
    ds_read_b128 v[84:87], v217 offset:0
    ds_read_b64_tr_b16 v[200:201], v220 offset:8192
    ds_read_b64_tr_b16 v[202:203], v220 offset:8704
    buffer_load_dwordx4 v225, s[8:11], s47 offen offset:1024 lds
    s_waitcnt lgkmcnt(3)
    v_mfma_f32_32x32x16_bf16 v[144:159], v[196:199], v[80:83], v[144:159]
    ds_read_b64_tr_b16 v[204:205], v220 offset:9216
    ds_read_b64_tr_b16 v[206:207], v220 offset:9728
    s_waitcnt lgkmcnt(2)
    v_mfma_f32_32x32x16_bf16 v[128:143], v[200:203], v[84:87], v[128:143]
    ds_read_b128 v[88:91], v218 offset:0
    ds_read_b64_tr_b16 v[192:193], v220 offset:16384
    ds_read_b64_tr_b16 v[194:195], v220 offset:16896
    buffer_load_dwordx4 v226, s[12:15], s55 offen offset:2048 lds
    s_waitcnt lgkmcnt(3)
    v_mfma_f32_32x32x16_bf16 v[144:159], v[204:207], v[84:87], v[144:159]
    ds_read_b64_tr_b16 v[196:197], v220 offset:17408
    ds_read_b64_tr_b16 v[198:199], v220 offset:17920
    s_waitcnt lgkmcnt(2)
    v_mfma_f32_32x32x16_bf16 v[128:143], v[192:195], v[88:91], v[128:143]
    ds_read_b128 v[92:95], v219 offset:0
    ds_read_b64_tr_b16 v[200:201], v220 offset:24576
    ds_read_b64_tr_b16 v[202:203], v220 offset:25088
    ds_read_b64_tr_b16 v[204:205], v220 offset:25600
    ds_read_b64_tr_b16 v[206:207], v220 offset:26112
    buffer_load_dwordx4 v226, s[12:15], s55 offen offset:3072 lds
    s_waitcnt lgkmcnt(5)
    v_mfma_f32_32x32x16_bf16 v[144:159], v[196:199], v[88:91], v[144:159]
    s_waitcnt vmcnt(4) lgkmcnt(0)
    s_barrier
    v_add_u32 v247, s79, v238
    v_add_u32 v252, s80, v238
    v_add_u32 v238, s78, v238
    v_add_u32 v253, s81, v253
    s_sub_u32 s40, s82, s81
    s_sub_u32 s48, s83, s82
    s_and_b32 s6, s70, 3
    s_lshl_b32 s78, s6, 15
    s_lshl_b32 s79, s6, 14
    s_and_b32 s80, s79, 0x4000
    s_lshr_b32 s81, s78, 4
    s_lshr_b32 s82, s79, 4
    s_lshr_b32 s83, s80, 4
    v_mfma_f32_32x32x16_bf16 v[128:143], v[200:203], v[92:95], v[128:143]
    ds_read_b128 v[96:99], v231 offset:0
    ds_read_b64_tr_b16 v[192:193], v235 offset:0
    ds_read_b64_tr_b16 v[194:195], v235 offset:512
    v_mfma_f32_32x32x16_bf16 v[144:159], v[204:207], v[92:95], v[144:159]
    ds_read_b64_tr_b16 v[196:197], v235 offset:1024
    ds_read_b64_tr_b16 v[198:199], v235 offset:1536
    s_add_u32 m0, s75, 98304
    s_nop 0
    buffer_load_dwordx4 v227, s[16:19], s56 offen offset:0 lds
    s_waitcnt lgkmcnt(2)
    v_mfma_f32_32x32x16_bf16 v[128:143], v[192:195], v[96:99], v[128:143]
    ds_read_b128 v[100:103], v232 offset:0
    ds_read_b64_tr_b16 v[200:201], v235 offset:8192
    ds_read_b64_tr_b16 v[202:203], v235 offset:8704
    s_waitcnt lgkmcnt(3)
    v_mfma_f32_32x32x16_bf16 v[144:159], v[196:199], v[96:99], v[144:159]
    ds_read_b64_tr_b16 v[204:205], v235 offset:9216
    ds_read_b64_tr_b16 v[206:207], v235 offset:9728
    buffer_load_dwordx4 v228, s[16:19], s56 offen offset:1024 lds
    s_waitcnt lgkmcnt(2)
    v_mfma_f32_32x32x16_bf16 v[128:143], v[200:203], v[100:103], v[128:143]
    ds_read_b128 v[104:107], v233 offset:0
    ds_read_b64_tr_b16 v[192:193], v235 offset:16384
    ds_read_b64_tr_b16 v[194:195], v235 offset:16896
    s_waitcnt lgkmcnt(3)
    v_mfma_f32_32x32x16_bf16 v[144:159], v[204:207], v[100:103], v[144:159]
    ds_read_b64_tr_b16 v[196:197], v235 offset:17408
    ds_read_b64_tr_b16 v[198:199], v235 offset:17920
    s_waitcnt lgkmcnt(2)
    v_mfma_f32_32x32x16_bf16 v[128:143], v[192:195], v[104:107], v[128:143]
    ds_read_b128 v[108:111], v234 offset:0
    ds_read_b64_tr_b16 v[200:201], v235 offset:24576
    ds_read_b64_tr_b16 v[202:203], v235 offset:25088
    ds_read_b64_tr_b16 v[204:205], v235 offset:25600
    ds_read_b64_tr_b16 v[206:207], v235 offset:26112
    s_bitcmp1_b32 s64, 0
    s_cbranch_scc1 L_od_5
    buffer_load_dwordx4 v229, s[16:19], s56 offen offset:2048 lds
L_od_5:
    s_waitcnt lgkmcnt(5)
    v_mfma_f32_32x32x16_bf16 v[144:159], v[196:199], v[104:107], v[144:159]
    s_waitcnt vmcnt(2) lgkmcnt(0)
    s_barrier
    v_mfma_f32_32x32x16_bf16 v[128:143], v[200:203], v[108:111], v[128:143]
    ds_read_b128 v[112:115], v231 offset:32768
    ds_read_b64_tr_b16 v[192:193], v235 offset:32768
    ds_read_b64_tr_b16 v[194:195], v235 offset:33280
    v_mfma_f32_32x32x16_bf16 v[144:159], v[204:207], v[108:111], v[144:159]
    ds_read_b64_tr_b16 v[196:197], v235 offset:33792
    ds_read_b64_tr_b16 v[198:199], v235 offset:34304
    s_add_u32 m0, s75, 118912
    s_nop 0
    buffer_load_dwordx4 v227, s[16:19], s57 offen offset:0 lds
    s_waitcnt lgkmcnt(2)
    v_mfma_f32_32x32x16_bf16 v[128:143], v[192:195], v[112:115], v[128:143]
    ds_read_b128 v[116:119], v232 offset:32768
    ds_read_b64_tr_b16 v[200:201], v235 offset:40960
    ds_read_b64_tr_b16 v[202:203], v235 offset:41472
    s_waitcnt lgkmcnt(3)
    v_mfma_f32_32x32x16_bf16 v[144:159], v[196:199], v[112:115], v[144:159]
    ds_read_b64_tr_b16 v[204:205], v235 offset:41984
    ds_read_b64_tr_b16 v[206:207], v235 offset:42496
    buffer_load_dwordx4 v228, s[16:19], s57 offen offset:1024 lds
    s_waitcnt lgkmcnt(2)
    v_mfma_f32_32x32x16_bf16 v[128:143], v[200:203], v[116:119], v[128:143]
    ds_read_b128 v[120:123], v233 offset:32768
    ds_read_b64_tr_b16 v[192:193], v235 offset:49152
    ds_read_b64_tr_b16 v[194:195], v235 offset:49664
    s_waitcnt lgkmcnt(3)
    v_mfma_f32_32x32x16_bf16 v[144:159], v[204:207], v[116:119], v[144:159]
    ds_read_b64_tr_b16 v[196:197], v235 offset:50176
    ds_read_b64_tr_b16 v[198:199], v235 offset:50688
    s_waitcnt lgkmcnt(2)
    v_mfma_f32_32x32x16_bf16 v[128:143], v[192:195], v[120:123], v[128:143]
    ds_read_b128 v[124:127], v234 offset:32768
    ds_read_b64_tr_b16 v[200:201], v235 offset:57344
    ds_read_b64_tr_b16 v[202:203], v235 offset:57856
    ds_read_b64_tr_b16 v[204:205], v235 offset:58368
    ds_read_b64_tr_b16 v[206:207], v235 offset:58880
    s_bitcmp1_b32 s64, 0
    s_cbranch_scc1 L_od_6
    buffer_load_dwordx4 v229, s[16:19], s57 offen offset:2048 lds
L_od_6:
    s_waitcnt lgkmcnt(5)
    v_mfma_f32_32x32x16_bf16 v[144:159], v[196:199], v[120:123], v[144:159]
    s_waitcnt lgkmcnt(2)
    v_mfma_f32_32x32x16_bf16 v[128:143], v[200:203], v[124:127], v[128:143]
    ds_read_b64_tr_b16 v[216:217], v170 offset:0
    ds_read_b64_tr_b16 v[218:219], v170 offset:128
    ds_read_b64_tr_b16 v[220:221], v170 offset:256
    ds_read_b64_tr_b16 v[222:223], v170 offset:384
    s_waitcnt lgkmcnt(4)
    v_mfma_f32_32x32x16_bf16 v[144:159], v[204:207], v[124:127], v[144:159]
    s_nop 5
    v_cvt_pk_bf16_f32 v208, v128, v129
    v_cvt_pk_bf16_f32 v209, v130, v131
    v_cvt_pk_bf16_f32 v210, v132, v133
    v_cvt_pk_bf16_f32 v211, v134, v135
    v_cvt_pk_bf16_f32 v212, v136, v137
    v_cvt_pk_bf16_f32 v213, v138, v139
    v_cvt_pk_bf16_f32 v214, v140, v141
    v_cvt_pk_bf16_f32 v215, v142, v143
    s_add_u32 m0, s75, 65536
    s_nop 0
    buffer_load_dwordx4 v227, s[16:19], s58 offen offset:0 lds
    s_waitcnt lgkmcnt(2)
    v_mfma_f32_32x32x16_bf16 v[128:143], v[216:219], v[208:211], 0
    s_waitcnt lgkmcnt(0)
    v_mfma_f32_32x32x16_bf16 v[128:143], v[220:223], v[212:215], v[128:143]
    v_cvt_pk_bf16_f32 v208, v144, v145
    v_cvt_pk_bf16_f32 v209, v146, v147
    v_cvt_pk_bf16_f32 v210, v148, v149
    v_cvt_pk_bf16_f32 v211, v150, v151
    ds_write_b128 v160, v[208:211] offset:0
    v_cvt_pk_bf16_f32 v212, v152, v153
    v_cvt_pk_bf16_f32 v213, v154, v155
    v_cvt_pk_bf16_f32 v214, v156, v157
    v_cvt_pk_bf16_f32 v215, v158, v159
    ds_write_b128 v160, v[212:215] offset:16
    s_nop 1
    v_max3_f32 v240, v128, v129, v130
    v_min3_f32 v241, v128, v129, v130
    v_max3_f32 v240, v240, v131, v132
    v_min3_f32 v241, v241, v131, v132
    buffer_load_dwordx4 v228, s[16:19], s58 offen offset:1024 lds
    v_max3_f32 v240, v240, v133, v134
    v_min3_f32 v241, v241, v133, v134
    v_max3_f32 v240, v240, v135, v136
    v_min3_f32 v241, v241, v135, v136
    v_max3_f32 v240, v240, v137, v138
    v_min3_f32 v241, v241, v137, v138
    v_max3_f32 v240, v240, v139, v140
    v_min3_f32 v241, v241, v139, v140
    v_max3_f32 v240, v240, v141, v142
    v_min3_f32 v241, v241, v141, v142
    v_max_f32 v240, v240, v143
    v_min_f32 v241, v241, v143
    v_mul_f32 v240, 0xbfb8aa3b, v240
    v_mul_f32 v241, 0x3fb8aa3b, v241
    v_fmamk_f32 v144, v128, 0x3fb8aa3b, v240
    v_fmamk_f32 v145, v129, 0x3fb8aa3b, v240
    v_exp_f32 v144, v144
    s_bitcmp1_b32 s64, 0
    s_cbranch_scc1 L_od_7
    buffer_load_dwordx4 v229, s[16:19], s58 offen offset:2048 lds
L_od_7:
    v_fmamk_f32 v146, v130, 0x3fb8aa3b, v240
    v_exp_f32 v145, v145
    v_fmamk_f32 v147, v131, 0x3fb8aa3b, v240
    v_exp_f32 v146, v146
    v_add_f32 v242, v144, v145
    v_fmamk_f32 v148, v132, 0x3fb8aa3b, v240
    v_exp_f32 v147, v147
    v_add_f32 v242, v242, v146
    v_fmamk_f32 v149, v133, 0x3fb8aa3b, v240
    v_exp_f32 v148, v148
    v_add_f32 v242, v242, v147
    v_fmamk_f32 v150, v134, 0x3fb8aa3b, v240
    v_exp_f32 v149, v149
    v_add_f32 v242, v242, v148
    v_fmamk_f32 v151, v135, 0x3fb8aa3b, v240
    v_exp_f32 v150, v150
    s_add_u32 m0, s77, 90112
    s_xor_b32 s95, s79, 180224
    buffer_load_dwordx4 v238, s[20:23], s95 offen offset:0 lds
    v_add_f32 v242, v242, v149
    v_fmamk_f32 v152, v136, 0x3fb8aa3b, v240
    v_exp_f32 v151, v151
    v_add_f32 v242, v242, v150
    v_fmamk_f32 v153, v137, 0x3fb8aa3b, v240
    v_exp_f32 v152, v152
    v_add_f32 v242, v242, v151
    v_fmamk_f32 v154, v138, 0x3fb8aa3b, v240
    v_exp_f32 v153, v153
    v_add_f32 v242, v242, v152
    v_fmamk_f32 v155, v139, 0x3fb8aa3b, v240
    v_exp_f32 v154, v154
    v_add_f32 v242, v242, v153
    v_fmamk_f32 v156, v140, 0x3fb8aa3b, v240
    v_exp_f32 v155, v155
    v_add_f32 v242, v242, v154
    v_fmamk_f32 v157, v141, 0x3fb8aa3b, v240
    s_barrier
    v_exp_f32 v156, v156
    v_add_f32 v242, v242, v155
    v_fmamk_f32 v158, v142, 0x3fb8aa3b, v240
    v_exp_f32 v157, v157
    v_add_f32 v242, v242, v156
    v_fmamk_f32 v159, v143, 0x3fb8aa3b, v240
    v_exp_f32 v158, v158
    v_add_f32 v242, v242, v157
    v_exp_f32 v159, v159
    v_add_f32 v242, v242, v158
    v_add_f32 v242, v242, v159
    v_rcp_f32 v242, v242
    s_nop 0
    v_mul_f32 v144, v144, v242
    v_mul_f32 v145, v145, v242
    v_cvt_pk_bf16_f32 v216, v144, v145
    v_mul_f32 v146, v146, v242
    s_add_u32 m0, s77, 32768
    s_xor_b32 s95, s78, 0
    buffer_load_dwordx4 v238, s[20:23], s95 offen offset:0 lds
    v_mul_f32 v147, v147, v242
    v_cvt_pk_bf16_f32 v217, v146, v147
    v_mul_f32 v148, v148, v242
    v_mul_f32 v149, v149, v242
    v_cvt_pk_bf16_f32 v218, v148, v149
    v_mul_f32 v150, v150, v242
    v_mul_f32 v151, v151, v242
    v_cvt_pk_bf16_f32 v219, v150, v151
    ds_write_b128 v161, v[216:219] offset:0
    v_mul_f32 v152, v152, v242
    v_mul_f32 v153, v153, v242
    v_cvt_pk_bf16_f32 v220, v152, v153
    v_mul_f32 v154, v154, v242
    v_mul_f32 v155, v155, v242
    v_cvt_pk_bf16_f32 v221, v154, v155
    v_mul_f32 v156, v156, v242
    v_mul_f32 v157, v157, v242
    s_add_u32 m0, s77, 40960
    s_xor_b32 s95, s78, 16384
    buffer_load_dwordx4 v238, s[20:23], s95 offen offset:0 lds
    v_cvt_pk_bf16_f32 v222, v156, v157
    v_mul_f32 v158, v158, v242
    v_mul_f32 v159, v159, v242
    v_cvt_pk_bf16_f32 v223, v158, v159
    ds_write_b128 v162, v[220:223] offset:0
    v_fmamk_f32 v128, v128, 0xbfb8aa3b, v241
    v_fmamk_f32 v129, v129, 0xbfb8aa3b, v241
    v_exp_f32 v128, v128
    v_fmamk_f32 v130, v130, 0xbfb8aa3b, v241
    v_exp_f32 v129, v129
    v_fmamk_f32 v131, v131, 0xbfb8aa3b, v241
    v_exp_f32 v130, v130
    v_add_f32 v244, v128, v129
    v_fmamk_f32 v132, v132, 0xbfb8aa3b, v241
    v_exp_f32 v131, v131
    v_add_f32 v244, v244, v130
    v_fmamk_f32 v133, v133, 0xbfb8aa3b, v241
    s_add_u32 m0, s77, 49152
    s_xor_b32 s95, s78, 32768
    buffer_load_dwordx4 v238, s[20:23], s95 offen offset:0 lds
    v_exp_f32 v132, v132
    v_add_f32 v244, v244, v131
    v_fmamk_f32 v134, v134, 0xbfb8aa3b, v241
    v_exp_f32 v133, v133
    v_add_f32 v244, v244, v132
    v_fmamk_f32 v135, v135, 0xbfb8aa3b, v241
    v_exp_f32 v134, v134
    v_add_f32 v244, v244, v133
    v_fmamk_f32 v136, v136, 0xbfb8aa3b, v241
    v_exp_f32 v135, v135
    v_add_f32 v244, v244, v134
    v_fmamk_f32 v137, v137, 0xbfb8aa3b, v241
    v_exp_f32 v136, v136
    v_add_f32 v244, v244, v135
    v_fmamk_f32 v138, v138, 0xbfb8aa3b, v241
    v_exp_f32 v137, v137
    s_add_u32 m0, s77, 57344
    s_xor_b32 s95, s78, 49152
    buffer_load_dwordx4 v238, s[20:23], s95 offen offset:0 lds
    v_add_f32 v244, v244, v136
    v_fmamk_f32 v139, v139, 0xbfb8aa3b, v241
    v_exp_f32 v138, v138
    v_add_f32 v244, v244, v137
    v_fmamk_f32 v140, v140, 0xbfb8aa3b, v241
    v_exp_f32 v139, v139
    v_add_f32 v244, v244, v138
    v_fmamk_f32 v141, v141, 0xbfb8aa3b, v241
    v_exp_f32 v140, v140
    v_add_f32 v244, v244, v139
    v_fmamk_f32 v142, v142, 0xbfb8aa3b, v241
    v_exp_f32 v141, v141
    v_add_f32 v244, v244, v140
    v_fmamk_f32 v143, v143, 0xbfb8aa3b, v241
    v_exp_f32 v142, v142
    v_add_f32 v244, v244, v141
    v_exp_f32 v143, v143
    v_add_f32 v244, v244, v142
    v_add_f32 v244, v244, v143
    v_rcp_f32 v244, v244
    s_nop 0
    v_mul_f32 v128, v128, v244
    v_mul_f32 v129, v129, v244
    v_cvt_pk_bf16_f32 v208, v128, v129
    v_mul_f32 v130, v130, v244
    v_mul_f32 v131, v131, v244
    v_cvt_pk_bf16_f32 v209, v130, v131
    v_mul_f32 v132, v132, v244
    v_mul_f32 v133, v133, v244
    v_cvt_pk_bf16_f32 v210, v132, v133
    v_mul_f32 v134, v134, v244
    v_mul_f32 v135, v135, v244
    v_cvt_pk_bf16_f32 v211, v134, v135
    ds_write_b128 v163, v[208:211] offset:0
    v_mul_f32 v136, v136, v244
    v_mul_f32 v137, v137, v244
    v_cvt_pk_bf16_f32 v212, v136, v137
    v_mul_f32 v138, v138, v244
    v_mul_f32 v139, v139, v244
    v_cvt_pk_bf16_f32 v213, v138, v139
    v_mul_f32 v140, v140, v244
    v_mul_f32 v141, v141, v244
    v_cvt_pk_bf16_f32 v214, v140, v141
    v_mul_f32 v142, v142, v244
    v_mul_f32 v143, v143, v244
    v_cvt_pk_bf16_f32 v215, v142, v143
    ds_write_b128 v164, v[212:215] offset:0
    v_mov_b32 v240, v165
    v_mov_b32 v241, v166
    v_mov_b32 v242, v167
    v_mov_b32 v243, v168
    v_mov_b32 v251, v169
    v_mov_b32 v140, 0x3f803f80
    v_mov_b32 v141, 0x3f803f80
    v_mov_b32 v142, 0x3f803f80
    v_mov_b32 v143, 0x3f803f80
    s_waitcnt vmcnt(9) lgkmcnt(0)
    s_barrier
    s_cmp_eq_u32 s66, 0
    s_cbranch_scc0 L_a1
    ds_read_b64_tr_b16 v[192:193], v230 offset:32768
    ds_read_b64_tr_b16 v[194:195], v230 offset:33408
    ds_read_b64_tr_b16 v[196:197], v230 offset:32800
    ds_read_b64_tr_b16 v[198:199], v230 offset:33440
    ds_read_b64_tr_b16 v[200:201], v230 offset:32832
    ds_read_b64_tr_b16 v[202:203], v230 offset:33472
    s_waitcnt lgkmcnt(4)
    v_mfma_f32_32x32x16_bf16 v[144:159], v[192:195], v[0:3], 0
    ds_read_b64_tr_b16 v[136:137], v240 offset:0
    ds_read_b64_tr_b16 v[138:139], v241 offset:256
    ds_read_b64_tr_b16 v[216:217], v242 offset:0
    ds_read_b64_tr_b16 v[218:219], v242 offset:128
    s_waitcnt lgkmcnt(2)
    v_mfma_f32_16x16x32_bf16 v[132:135], v[136:139], v[140:143], 0
    s_waitcnt lgkmcnt(0)
    v_mfma_f32_16x16x32_bf16 v[128:131], v[136:139], v[216:219], 0
    ds_read_b64_tr_b16 v[204:205], v230 offset:35328
    ds_read_b64_tr_b16 v[206:207], v230 offset:35968
    v_mfma_f32_32x32x16_bf16 v[160:175], v[196:199], v[0:3], 0
    ds_read_b64_tr_b16 v[136:137], v240 offset:2048
    ds_read_b64_tr_b16 v[138:139], v241 offset:2304
    ds_read_b64_tr_b16 v[216:217], v242 offset:1024
    ds_read_b64_tr_b16 v[218:219], v242 offset:1152
    s_waitcnt lgkmcnt(2)
    v_mfma_f32_16x16x32_bf16 v[132:135], v[136:139], v[140:143], v[132:135]
    s_waitcnt lgkmcnt(0)
    v_mfma_f32_16x16x32_bf16 v[128:131], v[136:139], v[216:219], v[128:131]
    ds_read_b64_tr_b16 v[208:209], v230 offset:35360
    ds_read_b64_tr_b16 v[210:211], v230 offset:36000
    v_mfma_f32_32x32x16_bf16 v[176:191], v[200:203], v[0:3], 0
    ds_read_b64_tr_b16 v[136:137], v240 offset:4096
    ds_read_b64_tr_b16 v[138:139], v241 offset:4352
    ds_read_b64_tr_b16 v[216:217], v242 offset:2048
    ds_read_b64_tr_b16 v[218:219], v242 offset:2176
    s_waitcnt lgkmcnt(2)
    v_mfma_f32_16x16x32_bf16 v[132:135], v[136:139], v[140:143], v[132:135]
    s_waitcnt lgkmcnt(0)
    v_mfma_f32_16x16x32_bf16 v[128:131], v[136:139], v[216:219], v[128:131]
    ds_read_b64_tr_b16 v[212:213], v230 offset:35392
    ds_read_b64_tr_b16 v[214:215], v230 offset:36032
    v_mfma_f32_32x32x16_bf16 v[144:159], v[204:207], v[4:7], v[144:159]
    ds_read_b64_tr_b16 v[136:137], v240 offset:6144
    ds_read_b64_tr_b16 v[138:139], v241 offset:6400
    ds_read_b64_tr_b16 v[216:217], v242 offset:3072
    ds_read_b64_tr_b16 v[218:219], v242 offset:3200
    s_waitcnt lgkmcnt(2)
    v_mfma_f32_16x16x32_bf16 v[132:135], v[136:139], v[140:143], v[132:135]
    s_waitcnt lgkmcnt(0)
    v_mfma_f32_16x16x32_bf16 v[128:131], v[136:139], v[216:219], v[128:131]
    ds_read_b64_tr_b16 v[192:193], v230 offset:37888
    ds_read_b64_tr_b16 v[194:195], v230 offset:38528
    v_mfma_f32_32x32x16_bf16 v[160:175], v[208:211], v[4:7], v[160:175]
    s_nop 4
    v_cvt_pk_bf16_f32 v220, v128, v129
    v_cvt_pk_bf16_f32 v221, v130, v131
    v_cvt_pk_bf16_f32 v222, v132, v133
    v_cvt_pk_bf16_f32 v223, v134, v135
    buffer_store_dwordx2 v[220:221], v243, s[28:31], s88 offen sc1
    s_mov_b32 exec_lo, 0x000f000f
    s_mov_b32 exec_hi, 0x000f000f
    buffer_store_dwordx2 v[222:223], v251, s[28:31], s88 offen offset:512 sc1
    s_mov_b64 exec, -1
    ds_read_b64_tr_b16 v[196:197], v230 offset:37920
    ds_read_b64_tr_b16 v[198:199], v230 offset:38560
    v_mfma_f32_32x32x16_bf16 v[176:191], v[212:215], v[4:7], v[176:191]
    ds_read_b64_tr_b16 v[200:201], v230 offset:37952
    ds_read_b64_tr_b16 v[202:203], v230 offset:38592
    s_waitcnt lgkmcnt(4)
    v_mfma_f32_32x32x16_bf16 v[144:159], v[192:195], v[8:11], v[144:159]
    ds_read_b64_tr_b16 v[204:205], v230 offset:40448
    ds_read_b64_tr_b16 v[206:207], v230 offset:41088
    ds_read_b64_tr_b16 v[208:209], v230 offset:40480
    ds_read_b64_tr_b16 v[210:211], v230 offset:41120
    ds_read_b64_tr_b16 v[212:213], v230 offset:40512
    ds_read_b64_tr_b16 v[214:215], v230 offset:41152
    s_waitcnt lgkmcnt(8)
    v_mfma_f32_32x32x16_bf16 v[160:175], v[196:199], v[8:11], v[160:175]
    s_waitcnt lgkmcnt(6)
    v_mfma_f32_32x32x16_bf16 v[176:191], v[200:203], v[8:11], v[176:191]
    s_waitcnt vmcnt(4) lgkmcnt(0)
    s_barrier
    v_mfma_f32_32x32x16_bf16 v[144:159], v[204:207], v[12:15], v[144:159]
    ds_read_b64_tr_b16 v[192:193], v230 offset:53376
    ds_read_b64_tr_b16 v[194:195], v230 offset:54016
    s_add_u32 m0, s75, 98304
    s_nop 0
    buffer_load_dwordx4 v227, s[16:19], s59 offen offset:0 lds
    v_mfma_f32_32x32x16_bf16 v[160:175], v[208:211], v[12:15], v[160:175]
    ds_read_b64_tr_b16 v[196:197], v230 offset:53408
    ds_read_b64_tr_b16 v[198:199], v230 offset:54048
    v_mfma_f32_32x32x16_bf16 v[176:191], v[212:215], v[12:15], v[176:191]
    ds_read_b64_tr_b16 v[200:201], v230 offset:53440
    ds_read_b64_tr_b16 v[202:203], v230 offset:54080
    buffer_load_dwordx4 v228, s[16:19], s59 offen offset:1024 lds
    s_waitcnt lgkmcnt(4)
    v_mfma_f32_32x32x16_bf16 v[144:159], v[192:195], v[16:19], v[144:159]
    ds_read_b64_tr_b16 v[204:205], v230 offset:55936
    ds_read_b64_tr_b16 v[206:207], v230 offset:56576
    s_waitcnt lgkmcnt(4)
    v_mfma_f32_32x32x16_bf16 v[160:175], v[196:199], v[16:19], v[160:175]
    ds_read_b64_tr_b16 v[208:209], v230 offset:55968
    ds_read_b64_tr_b16 v[210:211], v230 offset:56608
    s_bitcmp1_b32 s64, 0
    s_cbranch_scc1 L_od_8
    buffer_load_dwordx4 v229, s[16:19], s59 offen offset:2048 lds
L_od_8:
    s_waitcnt lgkmcnt(4)
    v_mfma_f32_32x32x16_bf16 v[176:191], v[200:203], v[16:19], v[176:191]
    ds_read_b64_tr_b16 v[212:213], v230 offset:56000
    ds_read_b64_tr_b16 v[214:215], v230 offset:56640
    ds_read_b64_tr_b16 v[0:1], v236 offset:32768
    ds_read_b64_tr_b16 v[2:3], v236 offset:33792
    ds_read_b64_tr_b16 v[4:5], v237 offset:32768
    ds_read_b64_tr_b16 v[6:7], v237 offset:33792
    s_waitcnt lgkmcnt(8)
    v_mfma_f32_32x32x16_bf16 v[144:159], v[204:207], v[20:23], v[144:159]
    ds_read_b64_tr_b16 v[192:193], v230 offset:58496
    ds_read_b64_tr_b16 v[194:195], v230 offset:59136
    s_waitcnt lgkmcnt(8)
    v_mfma_f32_32x32x16_bf16 v[160:175], v[208:211], v[20:23], v[160:175]
    ds_read_b64_tr_b16 v[196:197], v230 offset:58528
    ds_read_b64_tr_b16 v[198:199], v230 offset:59168
    s_add_u32 m0, s77, 0
    s_xor_b32 s95, s78, 65536
    buffer_load_dwordx4 v238, s[20:23], s95 offen offset:0 lds
    s_waitcnt lgkmcnt(8)
    v_mfma_f32_32x32x16_bf16 v[176:191], v[212:215], v[20:23], v[176:191]
    ds_read_b64_tr_b16 v[200:201], v230 offset:58560
    ds_read_b64_tr_b16 v[202:203], v230 offset:59200
    s_waitcnt lgkmcnt(4)
    v_mfma_f32_32x32x16_bf16 v[144:159], v[192:195], v[24:27], v[144:159]
    ds_read_b64_tr_b16 v[204:205], v230 offset:61056
    ds_read_b64_tr_b16 v[206:207], v230 offset:61696
    ds_read_b64_tr_b16 v[208:209], v230 offset:61088
    ds_read_b64_tr_b16 v[210:211], v230 offset:61728
    ds_read_b64_tr_b16 v[212:213], v230 offset:61120
    ds_read_b64_tr_b16 v[214:215], v230 offset:61760
    ds_read_b64_tr_b16 v[8:9], v236 offset:40960
    ds_read_b64_tr_b16 v[10:11], v236 offset:41984
    ds_read_b64_tr_b16 v[12:13], v237 offset:40960
    ds_read_b64_tr_b16 v[14:15], v237 offset:41984
    s_waitcnt lgkmcnt(12)
    v_mfma_f32_32x32x16_bf16 v[160:175], v[196:199], v[24:27], v[160:175]
    s_waitcnt lgkmcnt(10)
    v_mfma_f32_32x32x16_bf16 v[176:191], v[200:203], v[24:27], v[176:191]
    s_add_u32 m0, s77, 8192
    s_xor_b32 s95, s78, 81920
    buffer_load_dwordx4 v238, s[20:23], s95 offen offset:0 lds
    s_waitcnt vmcnt(4) lgkmcnt(0)
    s_barrier
    buffer_store_dword v248, v249, s[28:31], s84 offen sc1
    v_mfma_f32_32x32x16_bf16 v[144:159], v[204:207], v[28:31], v[144:159]
    ds_read_b64_tr_b16 v[192:193], v230 offset:0
    ds_read_b64_tr_b16 v[194:195], v230 offset:640
    s_add_u32 m0, s75, 118912
    s_nop 0
    buffer_load_dwordx4 v227, s[16:19], s60 offen offset:0 lds
    v_mfma_f32_32x32x16_bf16 v[160:175], v[208:211], v[28:31], v[160:175]
    ds_read_b64_tr_b16 v[196:197], v230 offset:32
    ds_read_b64_tr_b16 v[198:199], v230 offset:672
    v_mfma_f32_32x32x16_bf16 v[176:191], v[212:215], v[28:31], v[176:191]
    ds_read_b64_tr_b16 v[200:201], v230 offset:64
    ds_read_b64_tr_b16 v[202:203], v230 offset:704
    buffer_load_dwordx4 v228, s[16:19], s60 offen offset:1024 lds
    s_waitcnt lgkmcnt(4)
    v_mfma_f32_32x32x16_bf16 v[144:159], v[192:195], v[32:35], v[144:159]
    ds_read_b64_tr_b16 v[204:205], v230 offset:2560
    ds_read_b64_tr_b16 v[206:207], v230 offset:3200
    s_bitcmp1_b32 s64, 0
    s_cbranch_scc1 L_od_9
    buffer_load_dwordx4 v229, s[16:19], s60 offen offset:2048 lds
L_od_9:
    s_waitcnt lgkmcnt(4)
    v_mfma_f32_32x32x16_bf16 v[160:175], v[196:199], v[32:35], v[160:175]
    ds_read_b64_tr_b16 v[208:209], v230 offset:2592
    ds_read_b64_tr_b16 v[210:211], v230 offset:3232
    s_waitcnt lgkmcnt(4)
    v_mfma_f32_32x32x16_bf16 v[176:191], v[200:203], v[32:35], v[176:191]
    ds_read_b64_tr_b16 v[212:213], v230 offset:2624
    ds_read_b64_tr_b16 v[214:215], v230 offset:3264
    ds_read_b64_tr_b16 v[16:17], v236 offset:49152
    ds_read_b64_tr_b16 v[18:19], v236 offset:50176
    ds_read_b64_tr_b16 v[20:21], v237 offset:49152
    ds_read_b64_tr_b16 v[22:23], v237 offset:50176
    s_waitcnt lgkmcnt(8)
    v_mfma_f32_32x32x16_bf16 v[144:159], v[204:207], v[36:39], v[144:159]
    ds_read_b64_tr_b16 v[192:193], v230 offset:5120
    ds_read_b64_tr_b16 v[194:195], v230 offset:5760
    s_add_u32 m0, s77, 16384
    s_xor_b32 s95, s78, 98304
    buffer_load_dwordx4 v238, s[20:23], s95 offen offset:0 lds
    s_waitcnt lgkmcnt(8)
    v_mfma_f32_32x32x16_bf16 v[160:175], v[208:211], v[36:39], v[160:175]
    ds_read_b64_tr_b16 v[196:197], v230 offset:5152
    ds_read_b64_tr_b16 v[198:199], v230 offset:5792
    s_waitcnt lgkmcnt(8)
    v_mfma_f32_32x32x16_bf16 v[176:191], v[212:215], v[36:39], v[176:191]
    ds_read_b64_tr_b16 v[200:201], v230 offset:5184
    ds_read_b64_tr_b16 v[202:203], v230 offset:5824
    ds_read_b64_tr_b16 v[24:25], v236 offset:57344
    ds_read_b64_tr_b16 v[26:27], v236 offset:58368
    ds_read_b64_tr_b16 v[28:29], v237 offset:57344
    ds_read_b64_tr_b16 v[30:31], v237 offset:58368
    s_waitcnt lgkmcnt(8)
    v_mfma_f32_32x32x16_bf16 v[144:159], v[192:195], v[40:43], v[144:159]
    ds_read_b64_tr_b16 v[204:205], v230 offset:7680
    ds_read_b64_tr_b16 v[206:207], v230 offset:8320
    ds_read_b64_tr_b16 v[208:209], v230 offset:7712
    ds_read_b64_tr_b16 v[210:211], v230 offset:8352
    ds_read_b64_tr_b16 v[212:213], v230 offset:7744
    ds_read_b64_tr_b16 v[214:215], v230 offset:8384
    s_add_u32 m0, s77, 24576
    s_xor_b32 s95, s78, 114688
    buffer_load_dwordx4 v238, s[20:23], s95 offen offset:0 lds
    s_waitcnt lgkmcnt(12)
    v_mfma_f32_32x32x16_bf16 v[160:175], v[196:199], v[40:43], v[160:175]
    s_waitcnt lgkmcnt(10)
    v_mfma_f32_32x32x16_bf16 v[176:191], v[200:203], v[40:43], v[176:191]
    s_add_u32 m0, s77, 32768
    s_xor_b32 s95, s79, 131072
    buffer_load_dwordx4 v238, s[20:23], s95 offen offset:0 lds
    s_waitcnt vmcnt(6) lgkmcnt(0)
    s_barrier
    v_mfma_f32_32x32x16_bf16 v[144:159], v[204:207], v[44:47], v[144:159]
    ds_read_b64_tr_b16 v[192:193], v230 offset:32768
    ds_read_b64_tr_b16 v[194:195], v230 offset:33408
    s_add_u32 m0, s75, 65536
    s_nop 0
    buffer_load_dwordx4 v227, s[16:19], s61 offen offset:0 lds
    v_mfma_f32_32x32x16_bf16 v[160:175], v[208:211], v[44:47], v[160:175]
    ds_read_b64_tr_b16 v[196:197], v230 offset:32800
    ds_read_b64_tr_b16 v[198:199], v230 offset:33440
    v_mfma_f32_32x32x16_bf16 v[176:191], v[212:215], v[44:47], v[176:191]
    ds_read_b64_tr_b16 v[200:201], v230 offset:32832
    ds_read_b64_tr_b16 v[202:203], v230 offset:33472
    buffer_load_dwordx4 v228, s[16:19], s61 offen offset:1024 lds
    s_waitcnt lgkmcnt(4)
    v_mfma_f32_32x32x16_bf16 v[144:159], v[192:195], v[48:51], v[144:159]
    ds_read_b64_tr_b16 v[204:205], v230 offset:35328
    ds_read_b64_tr_b16 v[206:207], v230 offset:35968
    s_waitcnt lgkmcnt(4)
    v_mfma_f32_32x32x16_bf16 v[160:175], v[196:199], v[48:51], v[160:175]
    ds_read_b64_tr_b16 v[208:209], v230 offset:35360
    ds_read_b64_tr_b16 v[210:211], v230 offset:36000
    s_bitcmp1_b32 s64, 0
    s_cbranch_scc1 L_od_10
    buffer_load_dwordx4 v229, s[16:19], s61 offen offset:2048 lds
L_od_10:
    s_waitcnt lgkmcnt(4)
    v_mfma_f32_32x32x16_bf16 v[176:191], v[200:203], v[48:51], v[176:191]
    ds_read_b64_tr_b16 v[212:213], v230 offset:35392
    ds_read_b64_tr_b16 v[214:215], v230 offset:36032
    s_waitcnt lgkmcnt(4)
    v_mfma_f32_32x32x16_bf16 v[144:159], v[204:207], v[52:55], v[144:159]
    ds_read_b64_tr_b16 v[192:193], v230 offset:37888
    ds_read_b64_tr_b16 v[194:195], v230 offset:38528
    ds_read_b64_tr_b16 v[32:33], v236 offset:0
    ds_read_b64_tr_b16 v[34:35], v236 offset:1024
    ds_read_b64_tr_b16 v[36:37], v237 offset:0
    ds_read_b64_tr_b16 v[38:39], v237 offset:1024
    s_waitcnt lgkmcnt(8)
    v_mfma_f32_32x32x16_bf16 v[160:175], v[208:211], v[52:55], v[160:175]
    ds_read_b64_tr_b16 v[196:197], v230 offset:37920
    ds_read_b64_tr_b16 v[198:199], v230 offset:38560
    s_waitcnt lgkmcnt(8)
    v_mfma_f32_32x32x16_bf16 v[176:191], v[212:215], v[52:55], v[176:191]
    ds_read_b64_tr_b16 v[200:201], v230 offset:37952
    ds_read_b64_tr_b16 v[202:203], v230 offset:38592
    s_add_u32 m0, s77, 40960
    s_xor_b32 s95, s79, 147456
    buffer_load_dwordx4 v238, s[20:23], s95 offen offset:0 lds
    s_waitcnt lgkmcnt(8)
    v_mfma_f32_32x32x16_bf16 v[144:159], v[192:195], v[56:59], v[144:159]
    ds_read_b64_tr_b16 v[204:205], v230 offset:40448
    ds_read_b64_tr_b16 v[206:207], v230 offset:41088
    ds_read_b64_tr_b16 v[208:209], v230 offset:40480
    ds_read_b64_tr_b16 v[210:211], v230 offset:41120
    ds_read_b64_tr_b16 v[212:213], v230 offset:40512
    ds_read_b64_tr_b16 v[214:215], v230 offset:41152
    s_waitcnt lgkmcnt(8)
    v_mfma_f32_32x32x16_bf16 v[160:175], v[196:199], v[56:59], v[160:175]
    ds_read_b64_tr_b16 v[40:41], v236 offset:8192
    ds_read_b64_tr_b16 v[42:43], v236 offset:9216
    ds_read_b64_tr_b16 v[44:45], v237 offset:8192
    ds_read_b64_tr_b16 v[46:47], v237 offset:9216
    s_waitcnt lgkmcnt(10)
    v_mfma_f32_32x32x16_bf16 v[176:191], v[200:203], v[56:59], v[176:191]
    s_waitcnt vmcnt(4) lgkmcnt(0)
    s_barrier
    v_mfma_f32_32x32x16_bf16 v[144:159], v[204:207], v[60:63], v[144:159]
    ds_read_b64_tr_b16 v[192:193], v230 offset:53376
    ds_read_b64_tr_b16 v[194:195], v230 offset:54016
    s_add_u32 m0, s75, 98304
    s_nop 0
    buffer_load_dwordx4 v227, s[16:19], s62 offen offset:0 lds
    v_mfma_f32_32x32x16_bf16 v[160:175], v[208:211], v[60:63], v[160:175]
    ds_read_b64_tr_b16 v[196:197], v230 offset:53408
    ds_read_b64_tr_b16 v[198:199], v230 offset:54048
    v_mfma_f32_32x32x16_bf16 v[176:191], v[212:215], v[60:63], v[176:191]
    ds_read_b64_tr_b16 v[200:201], v230 offset:53440
    ds_read_b64_tr_b16 v[202:203], v230 offset:54080
    buffer_load_dwordx4 v228, s[16:19], s62 offen offset:1024 lds
    s_waitcnt lgkmcnt(4)
    v_mfma_f32_32x32x16_bf16 v[144:159], v[192:195], v[64:67], v[144:159]
    ds_read_b64_tr_b16 v[204:205], v230 offset:55936
    ds_read_b64_tr_b16 v[206:207], v230 offset:56576
    s_bitcmp1_b32 s64, 0
    s_cbranch_scc1 L_od_11
    buffer_load_dwordx4 v229, s[16:19], s62 offen offset:2048 lds
L_od_11:
    s_waitcnt lgkmcnt(4)
    v_mfma_f32_32x32x16_bf16 v[160:175], v[196:199], v[64:67], v[160:175]
    ds_read_b64_tr_b16 v[208:209], v230 offset:55968
    ds_read_b64_tr_b16 v[210:211], v230 offset:56608
    s_waitcnt lgkmcnt(4)
    v_mfma_f32_32x32x16_bf16 v[176:191], v[200:203], v[64:67], v[176:191]
    ds_read_b64_tr_b16 v[212:213], v230 offset:56000
    ds_read_b64_tr_b16 v[214:215], v230 offset:56640
    ds_read_b64_tr_b16 v[48:49], v236 offset:16384
    ds_read_b64_tr_b16 v[50:51], v236 offset:17408
    ds_read_b64_tr_b16 v[52:53], v237 offset:16384
    ds_read_b64_tr_b16 v[54:55], v237 offset:17408
    s_waitcnt lgkmcnt(8)
    v_mfma_f32_32x32x16_bf16 v[144:159], v[204:207], v[68:71], v[144:159]
    ds_read_b64_tr_b16 v[192:193], v230 offset:58496
    ds_read_b64_tr_b16 v[194:195], v230 offset:59136
    s_add_u32 m0, s77, 0
    s_xor_b32 s95, s78, 114688
    buffer_load_dwordx4 v247, s[20:23], s95 offen offset:0 lds
    s_waitcnt lgkmcnt(8)
    v_mfma_f32_32x32x16_bf16 v[160:175], v[208:211], v[68:71], v[160:175]
    ds_read_b64_tr_b16 v[196:197], v230 offset:58528
    ds_read_b64_tr_b16 v[198:199], v230 offset:59168
    s_waitcnt lgkmcnt(8)
    v_mfma_f32_32x32x16_bf16 v[176:191], v[212:215], v[68:71], v[176:191]
    ds_read_b64_tr_b16 v[200:201], v230 offset:58560
    ds_read_b64_tr_b16 v[202:203], v230 offset:59200
    ds_read_b64_tr_b16 v[56:57], v236 offset:24576
    ds_read_b64_tr_b16 v[58:59], v236 offset:25600
    ds_read_b64_tr_b16 v[60:61], v237 offset:24576
    ds_read_b64_tr_b16 v[62:63], v237 offset:25600
    s_waitcnt lgkmcnt(8)
    v_mfma_f32_32x32x16_bf16 v[144:159], v[192:195], v[72:75], v[144:159]
    ds_read_b64_tr_b16 v[204:205], v230 offset:61056
    ds_read_b64_tr_b16 v[206:207], v230 offset:61696
    ds_read_b64_tr_b16 v[208:209], v230 offset:61088
    ds_read_b64_tr_b16 v[210:211], v230 offset:61728
    ds_read_b64_tr_b16 v[212:213], v230 offset:61120
    ds_read_b64_tr_b16 v[214:215], v230 offset:61760
    s_add_u32 m0, s77, 8192
    s_xor_b32 s95, s80, 131072
    buffer_load_dwordx4 v247, s[20:23], s95 offen offset:0 lds
    s_waitcnt lgkmcnt(12)
    v_mfma_f32_32x32x16_bf16 v[160:175], v[196:199], v[72:75], v[160:175]
    s_waitcnt lgkmcnt(10)
    v_mfma_f32_32x32x16_bf16 v[176:191], v[200:203], v[72:75], v[176:191]
    s_add_u32 m0, s77, 147968
    s_xor_b32 s95, s78, 98304
    buffer_load_dwordx4 v247, s[20:23], s95 offen offset:0 lds
    s_waitcnt vmcnt(5) lgkmcnt(0)
    s_barrier
    v_mfma_f32_32x32x16_bf16 v[144:159], v[204:207], v[76:79], v[144:159]
    ds_read_b64_tr_b16 v[192:193], v230 offset:0
    ds_read_b64_tr_b16 v[194:195], v230 offset:640
    s_add_u32 m0, s75, 118912
    s_nop 0
    buffer_load_dwordx4 v227, s[16:19], s63 offen offset:0 lds
    v_mfma_f32_32x32x16_bf16 v[160:175], v[208:211], v[76:79], v[160:175]
    ds_read_b64_tr_b16 v[196:197], v230 offset:32
    ds_read_b64_tr_b16 v[198:199], v230 offset:672
    v_mfma_f32_32x32x16_bf16 v[176:191], v[212:215], v[76:79], v[176:191]
    ds_read_b64_tr_b16 v[200:201], v230 offset:64
    ds_read_b64_tr_b16 v[202:203], v230 offset:704
    buffer_load_dwordx4 v228, s[16:19], s63 offen offset:1024 lds
    s_waitcnt lgkmcnt(4)
    v_mfma_f32_32x32x16_bf16 v[144:159], v[192:195], v[80:83], v[144:159]
    ds_read_b64_tr_b16 v[204:205], v230 offset:2560
    ds_read_b64_tr_b16 v[206:207], v230 offset:3200
    s_waitcnt lgkmcnt(4)
    v_mfma_f32_32x32x16_bf16 v[160:175], v[196:199], v[80:83], v[160:175]
    ds_read_b64_tr_b16 v[208:209], v230 offset:2592
    ds_read_b64_tr_b16 v[210:211], v230 offset:3232
    s_bitcmp1_b32 s64, 0
    s_cbranch_scc1 L_od_12
    buffer_load_dwordx4 v229, s[16:19], s63 offen offset:2048 lds
L_od_12:
    s_waitcnt lgkmcnt(4)
    v_mfma_f32_32x32x16_bf16 v[176:191], v[200:203], v[80:83], v[176:191]
    ds_read_b64_tr_b16 v[212:213], v230 offset:2624
    ds_read_b64_tr_b16 v[214:215], v230 offset:3264
    ds_read_b64_tr_b16 v[64:65], v236 offset:32768
    ds_read_b64_tr_b16 v[66:67], v236 offset:33792
    ds_read_b64_tr_b16 v[68:69], v237 offset:32768
    ds_read_b64_tr_b16 v[70:71], v237 offset:33792
    s_waitcnt lgkmcnt(8)
    v_mfma_f32_32x32x16_bf16 v[144:159], v[204:207], v[84:87], v[144:159]
    ds_read_b64_tr_b16 v[192:193], v230 offset:5120
    ds_read_b64_tr_b16 v[194:195], v230 offset:5760
    s_waitcnt lgkmcnt(8)
    v_mfma_f32_32x32x16_bf16 v[160:175], v[208:211], v[84:87], v[160:175]
    ds_read_b64_tr_b16 v[196:197], v230 offset:5152
    ds_read_b64_tr_b16 v[198:199], v230 offset:5792
    s_add_u32 m0, s77, 16384
    s_xor_b32 s95, s80, 147456
    buffer_load_dwordx4 v247, s[20:23], s95 offen offset:0 lds
    s_waitcnt lgkmcnt(8)
    v_mfma_f32_32x32x16_bf16 v[176:191], v[212:215], v[84:87], v[176:191]
    ds_read_b64_tr_b16 v[200:201], v230 offset:5184
    ds_read_b64_tr_b16 v[202:203], v230 offset:5824
    s_waitcnt lgkmcnt(4)
    v_mfma_f32_32x32x16_bf16 v[144:159], v[192:195], v[88:91], v[144:159]
    ds_read_b64_tr_b16 v[204:205], v230 offset:7680
    ds_read_b64_tr_b16 v[206:207], v230 offset:8320
    ds_read_b64_tr_b16 v[208:209], v230 offset:7712
    ds_read_b64_tr_b16 v[210:211], v230 offset:8352
    ds_read_b64_tr_b16 v[212:213], v230 offset:7744
    ds_read_b64_tr_b16 v[214:215], v230 offset:8384
    ds_read_b64_tr_b16 v[72:73], v236 offset:40960
    ds_read_b64_tr_b16 v[74:75], v236 offset:41984
    ds_read_b64_tr_b16 v[76:77], v237 offset:40960
    ds_read_b64_tr_b16 v[78:79], v237 offset:41984
    s_waitcnt lgkmcnt(12)
    v_mfma_f32_32x32x16_bf16 v[160:175], v[196:199], v[88:91], v[160:175]
    s_waitcnt lgkmcnt(10)
    v_mfma_f32_32x32x16_bf16 v[176:191], v[200:203], v[88:91], v[176:191]
    s_add_u32 m0, s77, 24576
    s_xor_b32 s95, s78, 0
    buffer_load_dwordx4 v252, s[24:27], s95 offen offset:0 lds
    s_waitcnt vmcnt(7) lgkmcnt(0)
    s_barrier
    v_mfma_f32_32x32x16_bf16 v[144:159], v[204:207], v[92:95], v[144:159]
    ds_read_b64_tr_b16 v[192:193], v230 offset:32768
    ds_read_b64_tr_b16 v[194:195], v230 offset:33408
    v_mfma_f32_32x32x16_bf16 v[160:175], v[208:211], v[92:95], v[160:175]
    ds_read_b64_tr_b16 v[196:197], v230 offset:32800
    ds_read_b64_tr_b16 v[198:199], v230 offset:33440
    v_mfma_f32_32x32x16_bf16 v[176:191], v[212:215], v[92:95], v[176:191]
    ds_read_b64_tr_b16 v[200:201], v230 offset:32832
    ds_read_b64_tr_b16 v[202:203], v230 offset:33472
    s_add_u32 m0, s77, 32768
    s_xor_b32 s95, s78, 16384
    buffer_load_dwordx4 v252, s[24:27], s95 offen offset:0 lds
    s_waitcnt lgkmcnt(4)
    v_mfma_f32_32x32x16_bf16 v[144:159], v[192:195], v[96:99], v[144:159]
    ds_read_b64_tr_b16 v[204:205], v230 offset:35328
    ds_read_b64_tr_b16 v[206:207], v230 offset:35968
    s_waitcnt lgkmcnt(4)
    v_mfma_f32_32x32x16_bf16 v[160:175], v[196:199], v[96:99], v[160:175]
    ds_read_b64_tr_b16 v[208:209], v230 offset:35360
    ds_read_b64_tr_b16 v[210:211], v230 offset:36000
    s_waitcnt lgkmcnt(4)
    v_mfma_f32_32x32x16_bf16 v[176:191], v[200:203], v[96:99], v[176:191]
    ds_read_b64_tr_b16 v[212:213], v230 offset:35392
    ds_read_b64_tr_b16 v[214:215], v230 offset:36032
    s_waitcnt lgkmcnt(4)
    v_mfma_f32_32x32x16_bf16 v[144:159], v[204:207], v[100:103], v[144:159]
    ds_read_b64_tr_b16 v[192:193], v230 offset:37888
    ds_read_b64_tr_b16 v[194:195], v230 offset:38528
    s_waitcnt lgkmcnt(4)
    v_mfma_f32_32x32x16_bf16 v[160:175], v[208:211], v[100:103], v[160:175]
    ds_read_b64_tr_b16 v[196:197], v230 offset:37920
    ds_read_b64_tr_b16 v[198:199], v230 offset:38560
    s_waitcnt lgkmcnt(4)
    v_mfma_f32_32x32x16_bf16 v[176:191], v[212:215], v[100:103], v[176:191]
    ds_read_b64_tr_b16 v[200:201], v230 offset:37952
    ds_read_b64_tr_b16 v[202:203], v230 offset:38592
    s_add_u32 m0, s77, 40960
    s_xor_b32 s95, s78, 32768
    buffer_load_dwordx4 v252, s[24:27], s95 offen offset:0 lds
    s_waitcnt lgkmcnt(4)
    v_mfma_f32_32x32x16_bf16 v[144:159], v[192:195], v[104:107], v[144:159]
    ds_read_b64_tr_b16 v[204:205], v230 offset:40448
    ds_read_b64_tr_b16 v[206:207], v230 offset:41088
    ds_read_b64_tr_b16 v[208:209], v230 offset:40480
    ds_read_b64_tr_b16 v[210:211], v230 offset:41120
    ds_read_b64_tr_b16 v[212:213], v230 offset:40512
    ds_read_b64_tr_b16 v[214:215], v230 offset:41152
    s_waitcnt lgkmcnt(8)
    v_mfma_f32_32x32x16_bf16 v[160:175], v[196:199], v[104:107], v[160:175]
    s_waitcnt lgkmcnt(6)
    v_mfma_f32_32x32x16_bf16 v[176:191], v[200:203], v[104:107], v[176:191]
    s_waitcnt vmcnt(4) lgkmcnt(0)
    s_barrier
    v_mfma_f32_32x32x16_bf16 v[144:159], v[204:207], v[108:111], v[144:159]
    ds_read_b64_tr_b16 v[192:193], v230 offset:53376
    ds_read_b64_tr_b16 v[194:195], v230 offset:54016
    v_mfma_f32_32x32x16_bf16 v[160:175], v[208:211], v[108:111], v[160:175]
    ds_read_b64_tr_b16 v[196:197], v230 offset:53408
    ds_read_b64_tr_b16 v[198:199], v230 offset:54048
    s_add_u32 m0, s77, 81920
    s_xor_b32 s95, s79, 163840
    buffer_load_dwordx4 v238, s[20:23], s95 offen offset:0 lds
    v_mfma_f32_32x32x16_bf16 v[176:191], v[212:215], v[108:111], v[176:191]
    ds_read_b64_tr_b16 v[200:201], v230 offset:53440
    ds_read_b64_tr_b16 v[202:203], v230 offset:54080
    ds_read_b64_tr_b16 v[204:205], v230 offset:55936
    ds_read_b64_tr_b16 v[206:207], v230 offset:56576
    ds_read_b64_tr_b16 v[208:209], v230 offset:58496
    ds_read_b64_tr_b16 v[210:211], v230 offset:59136
    ds_read_b64_tr_b16 v[212:213], v230 offset:61056
    ds_read_b64_tr_b16 v[214:215], v230 offset:61696
    s_waitcnt lgkmcnt(10)
    v_mfma_f32_32x32x16_bf16 v[144:159], v[192:195], v[112:115], v[144:159]
    ds_read_b64_tr_b16 v[192:193], v230 offset:55968
    ds_read_b64_tr_b16 v[194:195], v230 offset:56608
    s_waitcnt lgkmcnt(6)
    v_mfma_f32_32x32x16_bf16 v[144:159], v[204:207], v[116:119], v[144:159]
    s_add_u32 m0, s77, 98304
    s_xor_b32 s95, s78, 0
    buffer_load_dwordx4 v247, s[20:23], s95 offen offset:0 lds
    ds_read_b64_tr_b16 v[204:205], v230 offset:58528
    ds_read_b64_tr_b16 v[206:207], v230 offset:59168
    s_waitcnt lgkmcnt(6)
    v_mfma_f32_32x32x16_bf16 v[144:159], v[208:211], v[120:123], v[144:159]
    ds_read_b64_tr_b16 v[208:209], v230 offset:61088
    ds_read_b64_tr_b16 v[210:211], v230 offset:61728
    s_waitcnt lgkmcnt(6)
    v_mfma_f32_32x32x16_bf16 v[144:159], v[212:215], v[124:127], v[144:159]
    s_add_u32 m0, s77, 106496
    s_xor_b32 s95, s78, 16384
    buffer_load_dwordx4 v247, s[20:23], s95 offen offset:0 lds
    ds_read_b64_tr_b16 v[212:213], v230 offset:56000
    ds_read_b64_tr_b16 v[214:215], v230 offset:56640
    v_mfma_f32_32x32x16_bf16 v[160:175], v[196:199], v[112:115], v[160:175]
    ds_read_b64_tr_b16 v[196:197], v230 offset:58560
    ds_read_b64_tr_b16 v[198:199], v230 offset:59200
    s_waitcnt lgkmcnt(8)
    v_mfma_f32_32x32x16_bf16 v[160:175], v[192:195], v[116:119], v[160:175]
    s_nop 1
    v_mul_f32 v144, v144, v152
    v_mul_f32 v145, v145, v153
    v_mul_f32 v146, v146, v154
    v_mul_f32 v147, v147, v155
    v_mul_f32 v148, v148, v156
    ds_read_b64_tr_b16 v[192:193], v230 offset:61120
    ds_read_b64_tr_b16 v[194:195], v230 offset:61760
    s_waitcnt lgkmcnt(8)
    v_mfma_f32_32x32x16_bf16 v[160:175], v[204:207], v[120:123], v[160:175]
    s_cmp_lg_u32 s64, 0
    s_cbranch_scc1 L_pi_13
    s_add_u32 s97, s86, 0
    buffer_load_dword v251, v250, s[28:31], s97 offen sc1
L_pi_13:
    v_mul_f32 v149, v149, v157
    v_mul_f32 v150, v150, v158
    v_mul_f32 v151, v151, v159
    v_cvt_pk_bf16_f32 v128, v144, v145
    s_waitcnt lgkmcnt(6)
    v_mfma_f32_32x32x16_bf16 v[160:175], v[208:211], v[124:127], v[160:175]
    v_cvt_pk_bf16_f32 v129, v146, v147
    v_cvt_pk_bf16_f32 v130, v148, v149
    v_cvt_pk_bf16_f32 v131, v150, v151
    buffer_store_dwordx4 v[128:131], v239, s[28:31], 0 offen offset:0 sc1
    v_mfma_f32_32x32x16_bf16 v[176:191], v[200:203], v[112:115], v[176:191]
    s_waitcnt lgkmcnt(4)
    v_mfma_f32_32x32x16_bf16 v[176:191], v[212:215], v[116:119], v[176:191]
    s_nop 4
    v_mul_f32 v160, v160, v168
    v_mul_f32 v161, v161, v169
    v_mul_f32 v162, v162, v170
    v_mul_f32 v163, v163, v171
    v_mul_f32 v164, v164, v172
    s_waitcnt lgkmcnt(2)
    v_mfma_f32_32x32x16_bf16 v[176:191], v[196:199], v[120:123], v[176:191]
    v_mul_f32 v165, v165, v173
    v_mul_f32 v166, v166, v174
    v_mul_f32 v167, v167, v175
    v_cvt_pk_bf16_f32 v132, v160, v161
    s_waitcnt lgkmcnt(0)
    v_mfma_f32_32x32x16_bf16 v[176:191], v[192:195], v[124:127], v[176:191]
    v_cvt_pk_bf16_f32 v133, v162, v163
    v_cvt_pk_bf16_f32 v134, v164, v165
    v_cvt_pk_bf16_f32 v135, v166, v167
    buffer_store_dwordx4 v[132:135], v239, s[28:31], 0 offen offset:1024 sc1
    s_nop 7
    v_mul_f32 v176, v176, v184
    v_mul_f32 v177, v177, v185
    v_mul_f32 v178, v178, v186
    v_mul_f32 v179, v179, v187
    v_mul_f32 v180, v180, v188
    v_mul_f32 v181, v181, v189
    v_mul_f32 v182, v182, v190
    v_mul_f32 v183, v183, v191
    v_cvt_pk_bf16_f32 v136, v176, v177
    v_cvt_pk_bf16_f32 v137, v178, v179
    v_cvt_pk_bf16_f32 v138, v180, v181
    v_cvt_pk_bf16_f32 v139, v182, v183
    buffer_store_dwordx4 v[136:139], v239, s[28:31], 0 offen offset:2048 sc1
    s_branch L_a2
L_a1:
    ds_read_b64_tr_b16 v[192:193], v230 offset:32768
    ds_read_b64_tr_b16 v[194:195], v230 offset:33408
    ds_read_b64_tr_b16 v[196:197], v230 offset:32800
    ds_read_b64_tr_b16 v[198:199], v230 offset:33440
    s_waitcnt lgkmcnt(2)
    v_mfma_f32_32x32x16_bf16 v[144:159], v[192:195], v[0:3], 0
    ds_read_b64_tr_b16 v[136:137], v240 offset:0
    ds_read_b64_tr_b16 v[138:139], v241 offset:256
    ds_read_b64_tr_b16 v[216:217], v242 offset:0
    ds_read_b64_tr_b16 v[218:219], v242 offset:128
    s_waitcnt lgkmcnt(2)
    v_mfma_f32_16x16x32_bf16 v[132:135], v[136:139], v[140:143], 0
    s_waitcnt lgkmcnt(0)
    v_mfma_f32_16x16x32_bf16 v[128:131], v[136:139], v[216:219], 0
    ds_read_b64_tr_b16 v[136:137], v240 offset:2048
    ds_read_b64_tr_b16 v[138:139], v241 offset:2304
    ds_read_b64_tr_b16 v[216:217], v242 offset:1024
    ds_read_b64_tr_b16 v[200:201], v230 offset:35328
    ds_read_b64_tr_b16 v[202:203], v230 offset:35968
    v_mfma_f32_32x32x16_bf16 v[160:175], v[196:199], v[0:3], 0
    ds_read_b64_tr_b16 v[218:219], v242 offset:1152
    s_waitcnt lgkmcnt(4)
    v_mfma_f32_16x16x32_bf16 v[132:135], v[136:139], v[140:143], v[132:135]
    s_waitcnt lgkmcnt(0)
    v_mfma_f32_16x16x32_bf16 v[128:131], v[136:139], v[216:219], v[128:131]
    ds_read_b64_tr_b16 v[136:137], v240 offset:4096
    ds_read_b64_tr_b16 v[138:139], v241 offset:4352
    ds_read_b64_tr_b16 v[216:217], v242 offset:2048
    ds_read_b64_tr_b16 v[218:219], v242 offset:2176
    s_waitcnt lgkmcnt(2)
    v_mfma_f32_16x16x32_bf16 v[132:135], v[136:139], v[140:143], v[132:135]
    s_waitcnt lgkmcnt(0)
    v_mfma_f32_16x16x32_bf16 v[128:131], v[136:139], v[216:219], v[128:131]
    ds_read_b64_tr_b16 v[204:205], v230 offset:35360
    ds_read_b64_tr_b16 v[206:207], v230 offset:36000
    v_mfma_f32_32x32x16_bf16 v[144:159], v[200:203], v[4:7], v[144:159]
    ds_read_b64_tr_b16 v[136:137], v240 offset:6144
    ds_read_b64_tr_b16 v[138:139], v241 offset:6400
    ds_read_b64_tr_b16 v[216:217], v242 offset:3072
    ds_read_b64_tr_b16 v[218:219], v242 offset:3200
    s_waitcnt lgkmcnt(2)
    v_mfma_f32_16x16x32_bf16 v[132:135], v[136:139], v[140:143], v[132:135]
    s_waitcnt lgkmcnt(0)
    v_mfma_f32_16x16x32_bf16 v[128:131], v[136:139], v[216:219], v[128:131]
    s_nop 7
    v_cvt_pk_bf16_f32 v220, v128, v129
    v_cvt_pk_bf16_f32 v221, v130, v131
    v_cvt_pk_bf16_f32 v222, v132, v133
    ds_read_b64_tr_b16 v[192:193], v230 offset:37888
    ds_read_b64_tr_b16 v[194:195], v230 offset:38528
    v_mfma_f32_32x32x16_bf16 v[160:175], v[204:207], v[4:7], v[160:175]
    v_cvt_pk_bf16_f32 v223, v134, v135
    buffer_store_dwordx2 v[220:221], v243, s[28:31], s88 offen sc1
    s_mov_b32 exec_lo, 0x000f000f
    s_mov_b32 exec_hi, 0x000f000f
    buffer_store_dwordx2 v[222:223], v251, s[28:31], s88 offen offset:512 sc1
    s_mov_b64 exec, -1
    ds_read_b64_tr_b16 v[196:197], v230 offset:37920
    ds_read_b64_tr_b16 v[198:199], v230 offset:38560
    s_waitcnt lgkmcnt(2)
    v_mfma_f32_32x32x16_bf16 v[144:159], v[192:195], v[8:11], v[144:159]
    ds_read_b64_tr_b16 v[200:201], v230 offset:40448
    ds_read_b64_tr_b16 v[202:203], v230 offset:41088
    ds_read_b64_tr_b16 v[204:205], v230 offset:40480
    ds_read_b64_tr_b16 v[206:207], v230 offset:41120
    s_waitcnt lgkmcnt(4)
    v_mfma_f32_32x32x16_bf16 v[160:175], v[196:199], v[8:11], v[160:175]
    s_waitcnt vmcnt(4) lgkmcnt(0)
    s_barrier
    v_mfma_f32_32x32x16_bf16 v[144:159], v[200:203], v[12:15], v[144:159]
    ds_read_b64_tr_b16 v[192:193], v230 offset:53376
    ds_read_b64_tr_b16 v[194:195], v230 offset:54016
    s_add_u32 m0, s75, 98304
    s_nop 0
    buffer_load_dwordx4 v227, s[16:19], s59 offen offset:0 lds
    v_mfma_f32_32x32x16_bf16 v[160:175], v[204:207], v[12:15], v[160:175]
    ds_read_b64_tr_b16 v[196:197], v230 offset:53408
    ds_read_b64_tr_b16 v[198:199], v230 offset:54048
    buffer_load_dwordx4 v228, s[16:19], s59 offen offset:1024 lds
    s_waitcnt lgkmcnt(2)
    v_mfma_f32_32x32x16_bf16 v[144:159], v[192:195], v[16:19], v[144:159]
    ds_read_b64_tr_b16 v[200:201], v230 offset:55936
    ds_read_b64_tr_b16 v[202:203], v230 offset:56576
    s_bitcmp1_b32 s64, 0
    s_cbranch_scc1 L_od_15
    buffer_load_dwordx4 v229, s[16:19], s59 offen offset:2048 lds
L_od_15:
    s_waitcnt lgkmcnt(2)
    v_mfma_f32_32x32x16_bf16 v[160:175], v[196:199], v[16:19], v[160:175]
    ds_read_b64_tr_b16 v[204:205], v230 offset:55968
    ds_read_b64_tr_b16 v[206:207], v230 offset:56608
    ds_read_b64_tr_b16 v[0:1], v236 offset:32768
    ds_read_b64_tr_b16 v[2:3], v236 offset:33792
    ds_read_b64_tr_b16 v[4:5], v237 offset:32768
    ds_read_b64_tr_b16 v[6:7], v237 offset:33792
    s_waitcnt lgkmcnt(6)
    v_mfma_f32_32x32x16_bf16 v[144:159], v[200:203], v[20:23], v[144:159]
    ds_read_b64_tr_b16 v[192:193], v230 offset:58496
    ds_read_b64_tr_b16 v[194:195], v230 offset:59136
    s_waitcnt lgkmcnt(6)
    v_mfma_f32_32x32x16_bf16 v[160:175], v[204:207], v[20:23], v[160:175]
    ds_read_b64_tr_b16 v[196:197], v230 offset:58528
    ds_read_b64_tr_b16 v[198:199], v230 offset:59168
    s_add_u32 m0, s77, 0
    s_xor_b32 s95, s78, 65536
    buffer_load_dwordx4 v238, s[20:23], s95 offen offset:0 lds
    s_waitcnt lgkmcnt(2)
    v_mfma_f32_32x32x16_bf16 v[144:159], v[192:195], v[24:27], v[144:159]
    ds_read_b64_tr_b16 v[200:201], v230 offset:61056
    ds_read_b64_tr_b16 v[202:203], v230 offset:61696
    ds_read_b64_tr_b16 v[204:205], v230 offset:61088
    ds_read_b64_tr_b16 v[206:207], v230 offset:61728
    ds_read_b64_tr_b16 v[8:9], v236 offset:40960
    ds_read_b64_tr_b16 v[10:11], v236 offset:41984
    ds_read_b64_tr_b16 v[12:13], v237 offset:40960
    ds_read_b64_tr_b16 v[14:15], v237 offset:41984
    s_waitcnt lgkmcnt(8)
    v_mfma_f32_32x32x16_bf16 v[160:175], v[196:199], v[24:27], v[160:175]
    s_add_u32 m0, s77, 8192
    s_xor_b32 s95, s78, 81920
    buffer_load_dwordx4 v238, s[20:23], s95 offen offset:0 lds
    s_waitcnt vmcnt(4) lgkmcnt(0)
    s_barrier
    buffer_store_dword v248, v249, s[28:31], s84 offen sc1
    v_mfma_f32_32x32x16_bf16 v[144:159], v[200:203], v[28:31], v[144:159]
    ds_read_b64_tr_b16 v[192:193], v230 offset:0
    ds_read_b64_tr_b16 v[194:195], v230 offset:640
    s_add_u32 m0, s75, 118912
    s_nop 0
    buffer_load_dwordx4 v227, s[16:19], s60 offen offset:0 lds
    v_mfma_f32_32x32x16_bf16 v[160:175], v[204:207], v[28:31], v[160:175]
    ds_read_b64_tr_b16 v[196:197], v230 offset:32
    ds_read_b64_tr_b16 v[198:199], v230 offset:672
    buffer_load_dwordx4 v228, s[16:19], s60 offen offset:1024 lds
    s_waitcnt lgkmcnt(2)
    v_mfma_f32_32x32x16_bf16 v[144:159], v[192:195], v[32:35], v[144:159]
    ds_read_b64_tr_b16 v[200:201], v230 offset:2560
    ds_read_b64_tr_b16 v[202:203], v230 offset:3200
    s_bitcmp1_b32 s64, 0
    s_cbranch_scc1 L_od_16
    buffer_load_dwordx4 v229, s[16:19], s60 offen offset:2048 lds
L_od_16:
    s_waitcnt lgkmcnt(2)
    v_mfma_f32_32x32x16_bf16 v[160:175], v[196:199], v[32:35], v[160:175]
    ds_read_b64_tr_b16 v[204:205], v230 offset:2592
    ds_read_b64_tr_b16 v[206:207], v230 offset:3232
    ds_read_b64_tr_b16 v[16:17], v236 offset:49152
    ds_read_b64_tr_b16 v[18:19], v236 offset:50176
    ds_read_b64_tr_b16 v[20:21], v237 offset:49152
    ds_read_b64_tr_b16 v[22:23], v237 offset:50176
    s_waitcnt lgkmcnt(6)
    v_mfma_f32_32x32x16_bf16 v[144:159], v[200:203], v[36:39], v[144:159]
    ds_read_b64_tr_b16 v[192:193], v230 offset:5120
    ds_read_b64_tr_b16 v[194:195], v230 offset:5760
    s_add_u32 m0, s77, 16384
    s_xor_b32 s95, s78, 98304
    buffer_load_dwordx4 v238, s[20:23], s95 offen offset:0 lds
    s_waitcnt lgkmcnt(6)
    v_mfma_f32_32x32x16_bf16 v[160:175], v[204:207], v[36:39], v[160:175]
    ds_read_b64_tr_b16 v[196:197], v230 offset:5152
    ds_read_b64_tr_b16 v[198:199], v230 offset:5792
    ds_read_b64_tr_b16 v[24:25], v236 offset:57344
    ds_read_b64_tr_b16 v[26:27], v236 offset:58368
    ds_read_b64_tr_b16 v[28:29], v237 offset:57344
    ds_read_b64_tr_b16 v[30:31], v237 offset:58368
    s_waitcnt lgkmcnt(6)
    v_mfma_f32_32x32x16_bf16 v[144:159], v[192:195], v[40:43], v[144:159]
    ds_read_b64_tr_b16 v[200:201], v230 offset:7680
    ds_read_b64_tr_b16 v[202:203], v230 offset:8320
    ds_read_b64_tr_b16 v[204:205], v230 offset:7712
    ds_read_b64_tr_b16 v[206:207], v230 offset:8352
    s_add_u32 m0, s77, 24576
    s_xor_b32 s95, s78, 114688
    buffer_load_dwordx4 v238, s[20:23], s95 offen offset:0 lds
    s_waitcnt lgkmcnt(8)
    v_mfma_f32_32x32x16_bf16 v[160:175], v[196:199], v[40:43], v[160:175]
    s_add_u32 m0, s77, 32768
    s_xor_b32 s95, s79, 131072
    buffer_load_dwordx4 v238, s[20:23], s95 offen offset:0 lds
    s_waitcnt vmcnt(6) lgkmcnt(0)
    s_barrier
    v_mfma_f32_32x32x16_bf16 v[144:159], v[200:203], v[44:47], v[144:159]
    ds_read_b64_tr_b16 v[192:193], v230 offset:32768
    ds_read_b64_tr_b16 v[194:195], v230 offset:33408
    s_add_u32 m0, s75, 65536
    s_nop 0
    buffer_load_dwordx4 v227, s[16:19], s61 offen offset:0 lds
    v_mfma_f32_32x32x16_bf16 v[160:175], v[204:207], v[44:47], v[160:175]
    ds_read_b64_tr_b16 v[196:197], v230 offset:32800
    ds_read_b64_tr_b16 v[198:199], v230 offset:33440
    buffer_load_dwordx4 v228, s[16:19], s61 offen offset:1024 lds
    s_waitcnt lgkmcnt(2)
    v_mfma_f32_32x32x16_bf16 v[144:159], v[192:195], v[48:51], v[144:159]
    ds_read_b64_tr_b16 v[200:201], v230 offset:35328
    ds_read_b64_tr_b16 v[202:203], v230 offset:35968
    s_waitcnt lgkmcnt(2)
    v_mfma_f32_32x32x16_bf16 v[160:175], v[196:199], v[48:51], v[160:175]
    ds_read_b64_tr_b16 v[204:205], v230 offset:35360
    ds_read_b64_tr_b16 v[206:207], v230 offset:36000
    s_bitcmp1_b32 s64, 0
    s_cbranch_scc1 L_od_17
    buffer_load_dwordx4 v229, s[16:19], s61 offen offset:2048 lds
L_od_17:
    s_waitcnt lgkmcnt(2)
    v_mfma_f32_32x32x16_bf16 v[144:159], v[200:203], v[52:55], v[144:159]
    ds_read_b64_tr_b16 v[192:193], v230 offset:37888
    ds_read_b64_tr_b16 v[194:195], v230 offset:38528
    ds_read_b64_tr_b16 v[32:33], v236 offset:0
    ds_read_b64_tr_b16 v[34:35], v236 offset:1024
    ds_read_b64_tr_b16 v[36:37], v237 offset:0
    ds_read_b64_tr_b16 v[38:39], v237 offset:1024
    s_waitcnt lgkmcnt(6)
    v_mfma_f32_32x32x16_bf16 v[160:175], v[204:207], v[52:55], v[160:175]
    ds_read_b64_tr_b16 v[196:197], v230 offset:37920
    ds_read_b64_tr_b16 v[198:199], v230 offset:38560
    s_add_u32 m0, s77, 40960
    s_xor_b32 s95, s79, 147456
    buffer_load_dwordx4 v238, s[20:23], s95 offen offset:0 lds
    s_waitcnt lgkmcnt(6)
    v_mfma_f32_32x32x16_bf16 v[144:159], v[192:195], v[56:59], v[144:159]
    ds_read_b64_tr_b16 v[200:201], v230 offset:40448
    ds_read_b64_tr_b16 v[202:203], v230 offset:41088
    ds_read_b64_tr_b16 v[204:205], v230 offset:40480
    ds_read_b64_tr_b16 v[206:207], v230 offset:41120
    s_waitcnt lgkmcnt(4)
    v_mfma_f32_32x32x16_bf16 v[160:175], v[196:199], v[56:59], v[160:175]
    ds_read_b64_tr_b16 v[40:41], v236 offset:8192
    ds_read_b64_tr_b16 v[42:43], v236 offset:9216
    ds_read_b64_tr_b16 v[44:45], v237 offset:8192
    ds_read_b64_tr_b16 v[46:47], v237 offset:9216
    s_waitcnt vmcnt(4) lgkmcnt(0)
    s_barrier
    v_mfma_f32_32x32x16_bf16 v[144:159], v[200:203], v[60:63], v[144:159]
    ds_read_b64_tr_b16 v[192:193], v230 offset:53376
    ds_read_b64_tr_b16 v[194:195], v230 offset:54016
    s_add_u32 m0, s75, 98304
    s_nop 0
    buffer_load_dwordx4 v227, s[16:19], s62 offen offset:0 lds
    v_mfma_f32_32x32x16_bf16 v[160:175], v[204:207], v[60:63], v[160:175]
    ds_read_b64_tr_b16 v[196:197], v230 offset:53408
    ds_read_b64_tr_b16 v[198:199], v230 offset:54048
    buffer_load_dwordx4 v228, s[16:19], s62 offen offset:1024 lds
    s_waitcnt lgkmcnt(2)
    v_mfma_f32_32x32x16_bf16 v[144:159], v[192:195], v[64:67], v[144:159]
    ds_read_b64_tr_b16 v[200:201], v230 offset:55936
    ds_read_b64_tr_b16 v[202:203], v230 offset:56576
    s_bitcmp1_b32 s64, 0
    s_cbranch_scc1 L_od_18
    buffer_load_dwordx4 v229, s[16:19], s62 offen offset:2048 lds
L_od_18:
    s_waitcnt lgkmcnt(2)
    v_mfma_f32_32x32x16_bf16 v[160:175], v[196:199], v[64:67], v[160:175]
    ds_read_b64_tr_b16 v[204:205], v230 offset:55968
    ds_read_b64_tr_b16 v[206:207], v230 offset:56608
    ds_read_b64_tr_b16 v[48:49], v236 offset:16384
    ds_read_b64_tr_b16 v[50:51], v236 offset:17408
    ds_read_b64_tr_b16 v[52:53], v237 offset:16384
    ds_read_b64_tr_b16 v[54:55], v237 offset:17408
    s_waitcnt lgkmcnt(6)
    v_mfma_f32_32x32x16_bf16 v[144:159], v[200:203], v[68:71], v[144:159]
    ds_read_b64_tr_b16 v[192:193], v230 offset:58496
    ds_read_b64_tr_b16 v[194:195], v230 offset:59136
    s_add_u32 m0, s77, 0
    s_xor_b32 s95, s78, 114688
    buffer_load_dwordx4 v247, s[20:23], s95 offen offset:0 lds
    s_waitcnt lgkmcnt(6)
    v_mfma_f32_32x32x16_bf16 v[160:175], v[204:207], v[68:71], v[160:175]
    ds_read_b64_tr_b16 v[196:197], v230 offset:58528
    ds_read_b64_tr_b16 v[198:199], v230 offset:59168
    ds_read_b64_tr_b16 v[56:57], v236 offset:24576
    ds_read_b64_tr_b16 v[58:59], v236 offset:25600
    ds_read_b64_tr_b16 v[60:61], v237 offset:24576
    ds_read_b64_tr_b16 v[62:63], v237 offset:25600
    s_waitcnt lgkmcnt(6)
    v_mfma_f32_32x32x16_bf16 v[144:159], v[192:195], v[72:75], v[144:159]
    ds_read_b64_tr_b16 v[200:201], v230 offset:61056
    ds_read_b64_tr_b16 v[202:203], v230 offset:61696
    ds_read_b64_tr_b16 v[204:205], v230 offset:61088
    ds_read_b64_tr_b16 v[206:207], v230 offset:61728
    s_add_u32 m0, s77, 8192
    s_xor_b32 s95, s80, 131072
    buffer_load_dwordx4 v247, s[20:23], s95 offen offset:0 lds
    s_waitcnt lgkmcnt(8)
    v_mfma_f32_32x32x16_bf16 v[160:175], v[196:199], v[72:75], v[160:175]
    s_add_u32 m0, s77, 147968
    s_xor_b32 s95, s78, 98304
    buffer_load_dwordx4 v247, s[20:23], s95 offen offset:0 lds
    s_waitcnt vmcnt(5) lgkmcnt(0)
    s_barrier
    v_mfma_f32_32x32x16_bf16 v[144:159], v[200:203], v[76:79], v[144:159]
    ds_read_b64_tr_b16 v[192:193], v230 offset:0
    ds_read_b64_tr_b16 v[194:195], v230 offset:640
    s_add_u32 m0, s75, 118912
    s_nop 0
    buffer_load_dwordx4 v227, s[16:19], s63 offen offset:0 lds
    v_mfma_f32_32x32x16_bf16 v[160:175], v[204:207], v[76:79], v[160:175]
    ds_read_b64_tr_b16 v[196:197], v230 offset:32
    ds_read_b64_tr_b16 v[198:199], v230 offset:672
    buffer_load_dwordx4 v228, s[16:19], s63 offen offset:1024 lds
    s_waitcnt lgkmcnt(2)
    v_mfma_f32_32x32x16_bf16 v[144:159], v[192:195], v[80:83], v[144:159]
    ds_read_b64_tr_b16 v[200:201], v230 offset:2560
    ds_read_b64_tr_b16 v[202:203], v230 offset:3200
    s_bitcmp1_b32 s64, 0
    s_cbranch_scc1 L_od_19
    buffer_load_dwordx4 v229, s[16:19], s63 offen offset:2048 lds
L_od_19:
    s_waitcnt lgkmcnt(2)
    v_mfma_f32_32x32x16_bf16 v[160:175], v[196:199], v[80:83], v[160:175]
    ds_read_b64_tr_b16 v[204:205], v230 offset:2592
    ds_read_b64_tr_b16 v[206:207], v230 offset:3232
    ds_read_b64_tr_b16 v[64:65], v236 offset:32768
    ds_read_b64_tr_b16 v[66:67], v236 offset:33792
    ds_read_b64_tr_b16 v[68:69], v237 offset:32768
    ds_read_b64_tr_b16 v[70:71], v237 offset:33792
    s_waitcnt lgkmcnt(6)
    v_mfma_f32_32x32x16_bf16 v[144:159], v[200:203], v[84:87], v[144:159]
    ds_read_b64_tr_b16 v[192:193], v230 offset:5120
    ds_read_b64_tr_b16 v[194:195], v230 offset:5760
    s_waitcnt lgkmcnt(6)
    v_mfma_f32_32x32x16_bf16 v[160:175], v[204:207], v[84:87], v[160:175]
    ds_read_b64_tr_b16 v[196:197], v230 offset:5152
    ds_read_b64_tr_b16 v[198:199], v230 offset:5792
    s_add_u32 m0, s77, 16384
    s_xor_b32 s95, s80, 147456
    buffer_load_dwordx4 v247, s[20:23], s95 offen offset:0 lds
    s_waitcnt lgkmcnt(2)
    v_mfma_f32_32x32x16_bf16 v[144:159], v[192:195], v[88:91], v[144:159]
    ds_read_b64_tr_b16 v[200:201], v230 offset:7680
    ds_read_b64_tr_b16 v[202:203], v230 offset:8320
    ds_read_b64_tr_b16 v[204:205], v230 offset:7712
    ds_read_b64_tr_b16 v[206:207], v230 offset:8352
    ds_read_b64_tr_b16 v[72:73], v236 offset:40960
    ds_read_b64_tr_b16 v[74:75], v236 offset:41984
    ds_read_b64_tr_b16 v[76:77], v237 offset:40960
    ds_read_b64_tr_b16 v[78:79], v237 offset:41984
    s_waitcnt lgkmcnt(8)
    v_mfma_f32_32x32x16_bf16 v[160:175], v[196:199], v[88:91], v[160:175]
    s_add_u32 m0, s77, 24576
    s_xor_b32 s95, s78, 0
    buffer_load_dwordx4 v252, s[24:27], s95 offen offset:0 lds
    s_waitcnt vmcnt(7) lgkmcnt(0)
    s_barrier
    v_mfma_f32_32x32x16_bf16 v[144:159], v[200:203], v[92:95], v[144:159]
    ds_read_b64_tr_b16 v[192:193], v230 offset:32768
    ds_read_b64_tr_b16 v[194:195], v230 offset:33408
    v_mfma_f32_32x32x16_bf16 v[160:175], v[204:207], v[92:95], v[160:175]
    ds_read_b64_tr_b16 v[196:197], v230 offset:32800
    ds_read_b64_tr_b16 v[198:199], v230 offset:33440
    s_add_u32 m0, s77, 32768
    s_xor_b32 s95, s78, 16384
    buffer_load_dwordx4 v252, s[24:27], s95 offen offset:0 lds
    s_waitcnt lgkmcnt(2)
    v_mfma_f32_32x32x16_bf16 v[144:159], v[192:195], v[96:99], v[144:159]
    ds_read_b64_tr_b16 v[200:201], v230 offset:35328
    ds_read_b64_tr_b16 v[202:203], v230 offset:35968
    s_waitcnt lgkmcnt(2)
    v_mfma_f32_32x32x16_bf16 v[160:175], v[196:199], v[96:99], v[160:175]
    ds_read_b64_tr_b16 v[204:205], v230 offset:35360
    ds_read_b64_tr_b16 v[206:207], v230 offset:36000
    s_waitcnt lgkmcnt(2)
    v_mfma_f32_32x32x16_bf16 v[144:159], v[200:203], v[100:103], v[144:159]
    ds_read_b64_tr_b16 v[192:193], v230 offset:37888
    ds_read_b64_tr_b16 v[194:195], v230 offset:38528
    s_waitcnt lgkmcnt(2)
    v_mfma_f32_32x32x16_bf16 v[160:175], v[204:207], v[100:103], v[160:175]
    ds_read_b64_tr_b16 v[196:197], v230 offset:37920
    ds_read_b64_tr_b16 v[198:199], v230 offset:38560
    s_add_u32 m0, s77, 40960
    s_xor_b32 s95, s78, 32768
    buffer_load_dwordx4 v252, s[24:27], s95 offen offset:0 lds
    s_waitcnt lgkmcnt(2)
    v_mfma_f32_32x32x16_bf16 v[144:159], v[192:195], v[104:107], v[144:159]
    ds_read_b64_tr_b16 v[200:201], v230 offset:40448
    ds_read_b64_tr_b16 v[202:203], v230 offset:41088
    ds_read_b64_tr_b16 v[204:205], v230 offset:40480
    ds_read_b64_tr_b16 v[206:207], v230 offset:41120
    s_waitcnt lgkmcnt(4)
    v_mfma_f32_32x32x16_bf16 v[160:175], v[196:199], v[104:107], v[160:175]
    s_waitcnt vmcnt(4) lgkmcnt(0)
    s_barrier
    v_mfma_f32_32x32x16_bf16 v[144:159], v[200:203], v[108:111], v[144:159]
    ds_read_b64_tr_b16 v[192:193], v230 offset:53376
    ds_read_b64_tr_b16 v[194:195], v230 offset:54016
    v_mfma_f32_32x32x16_bf16 v[160:175], v[204:207], v[108:111], v[160:175]
    ds_read_b64_tr_b16 v[196:197], v230 offset:53408
    ds_read_b64_tr_b16 v[198:199], v230 offset:54048
    s_add_u32 m0, s77, 81920
    s_xor_b32 s95, s79, 163840
    buffer_load_dwordx4 v238, s[20:23], s95 offen offset:0 lds
    ds_read_b64_tr_b16 v[200:201], v230 offset:55936
    ds_read_b64_tr_b16 v[202:203], v230 offset:56576
    ds_read_b64_tr_b16 v[204:205], v230 offset:58496
    ds_read_b64_tr_b16 v[206:207], v230 offset:59136
    s_waitcnt lgkmcnt(6)
    v_mfma_f32_32x32x16_bf16 v[144:159], v[192:195], v[112:115], v[144:159]
    s_add_u32 m0, s77, 98304
    s_xor_b32 s95, s78, 0
    buffer_load_dwordx4 v247, s[20:23], s95 offen offset:0 lds
    ds_read_b64_tr_b16 v[192:193], v230 offset:61056
    ds_read_b64_tr_b16 v[194:195], v230 offset:61696
    s_waitcnt lgkmcnt(4)
    v_mfma_f32_32x32x16_bf16 v[144:159], v[200:203], v[116:119], v[144:159]
    s_add_u32 m0, s77, 106496
    s_xor_b32 s95, s78, 16384
    buffer_load_dwordx4 v247, s[20:23], s95 offen offset:0 lds
    ds_read_b64_tr_b16 v[200:201], v230 offset:55968
    ds_read_b64_tr_b16 v[202:203], v230 offset:56608
    s_waitcnt lgkmcnt(4)
    v_mfma_f32_32x32x16_bf16 v[144:159], v[204:207], v[120:123], v[144:159]
    ds_read_b64_tr_b16 v[204:205], v230 offset:58528
    ds_read_b64_tr_b16 v[206:207], v230 offset:59168
    s_waitcnt lgkmcnt(4)
    v_mfma_f32_32x32x16_bf16 v[144:159], v[192:195], v[124:127], v[144:159]
    s_cmp_lg_u32 s64, 0
    s_cbranch_scc1 L_pi_20
    s_add_u32 s97, s86, 0
    buffer_load_dword v251, v250, s[28:31], s97 offen sc1
L_pi_20:
    ds_read_b64_tr_b16 v[192:193], v230 offset:61088
    ds_read_b64_tr_b16 v[194:195], v230 offset:61728
    v_mfma_f32_32x32x16_bf16 v[160:175], v[196:199], v[112:115], v[160:175]
    s_waitcnt lgkmcnt(4)
    v_mfma_f32_32x32x16_bf16 v[160:175], v[200:203], v[116:119], v[160:175]
    s_nop 4
    v_mul_f32 v144, v144, v152
    v_mul_f32 v145, v145, v153
    v_mul_f32 v146, v146, v154
    v_mul_f32 v147, v147, v155
    v_mul_f32 v148, v148, v156
    s_waitcnt lgkmcnt(2)
    v_mfma_f32_32x32x16_bf16 v[160:175], v[204:207], v[120:123], v[160:175]
    v_mul_f32 v149, v149, v157
    v_mul_f32 v150, v150, v158
    v_mul_f32 v151, v151, v159
    v_cvt_pk_bf16_f32 v128, v144, v145
    s_waitcnt lgkmcnt(0)
    v_mfma_f32_32x32x16_bf16 v[160:175], v[192:195], v[124:127], v[160:175]
    v_cvt_pk_bf16_f32 v129, v146, v147
    v_cvt_pk_bf16_f32 v130, v148, v149
    v_cvt_pk_bf16_f32 v131, v150, v151
    buffer_store_dwordx4 v[128:131], v239, s[28:31], 0 offen offset:0 sc1
    s_nop 7
    v_mul_f32 v160, v160, v168
    v_mul_f32 v161, v161, v169
    v_mul_f32 v162, v162, v170
    v_mul_f32 v163, v163, v171
    v_mul_f32 v164, v164, v172
    v_mul_f32 v165, v165, v173
    v_mul_f32 v166, v166, v174
    v_mul_f32 v167, v167, v175
    v_cvt_pk_bf16_f32 v132, v160, v161
    v_cvt_pk_bf16_f32 v133, v162, v163
    v_cvt_pk_bf16_f32 v134, v164, v165
    v_cvt_pk_bf16_f32 v135, v166, v167
    s_cmp_lt_u32 s68, 6
    s_cbranch_scc1 L_sk_14
    v_mov_b32 v132, 0
    v_mov_b32 v133, 0
    v_mov_b32 v134, 0
    v_mov_b32 v135, 0
L_sk_14:
    buffer_store_dwordx4 v[132:135], v239, s[28:31], s90 offen sc1
L_a2:
    v_add_u32 v236, 65536, v236
    v_add_u32 v237, 65536, v237
    s_barrier
    s_add_u32 m0, s77, 114688
    s_xor_b32 s95, s78, 32768
    buffer_load_dwordx4 v247, s[20:23], s95 offen offset:0 lds
    s_add_u32 m0, s77, 122880
    s_xor_b32 s95, s78, 49152
    buffer_load_dwordx4 v247, s[20:23], s95 offen offset:0 lds
    s_add_u32 m0, s77, 131072
    s_xor_b32 s95, s78, 65536
    buffer_load_dwordx4 v247, s[20:23], s95 offen offset:0 lds
    s_add_u32 m0, s77, 139264
    s_xor_b32 s95, s78, 81920
    buffer_load_dwordx4 v247, s[20:23], s95 offen offset:0 lds
    s_branch L_phase2
L_typeB:
    s_waitcnt vmcnt(8) lgkmcnt(0)
    s_barrier
    ds_read_b128 v[0:3], v231 offset:0
    ds_read_b64_tr_b16 v[192:193], v230 offset:0
    ds_read_b64_tr_b16 v[194:195], v230 offset:768
    ds_read_b64_tr_b16 v[196:197], v230 offset:32
    ds_read_b64_tr_b16 v[198:199], v230 offset:800
    ds_read_b64_tr_b16 v[200:201], v230 offset:64
    ds_read_b64_tr_b16 v[202:203], v230 offset:832
    s_waitcnt lgkmcnt(4)
    v_mfma_f32_32x32x16_bf16 v[128:143], v[192:195], v[0:3], 0
    v_mov_b32 v32, 0
    s_waitcnt vmcnt(6)
    v_dot2c_f32_bf16 v32, v24, v28
    v_dot2c_f32_bf16 v32, v25, v29
    ds_read_b128 v[4:7], v232 offset:0
    ds_read_b64_tr_b16 v[204:205], v230 offset:3072
    ds_read_b64_tr_b16 v[206:207], v230 offset:3840
    s_add_u32 m0, s74, 81984
    s_nop 0
    buffer_load_dwordx4 v224, s[8:11], s42 offen offset:0 lds
    s_waitcnt lgkmcnt(5)
    v_mfma_f32_32x32x16_bf16 v[144:159], v[196:199], v[0:3], 0
    v_dot2c_f32_bf16 v32, v26, v30
    v_dot2c_f32_bf16 v32, v27, v31
    s_lshl_b32 s6, s64, 2
    s_add_u32 s6, s6, 163328
    ds_read_b64_tr_b16 v[208:209], v230 offset:3104
    ds_read_b64_tr_b16 v[210:211], v230 offset:3872
    s_waitcnt lgkmcnt(5)
    v_mfma_f32_32x32x16_bf16 v[160:175], v[200:203], v[0:3], 0
    v_mov_b32 v33, s6
    s_nop 2
    v_add_f32 v32, v32, v32 row_shr:1 bound_ctrl:0
    ds_read_b64_tr_b16 v[212:213], v230 offset:3136
    ds_read_b64_tr_b16 v[214:215], v230 offset:3904
    buffer_load_dwordx4 v225, s[8:11], s42 offen offset:1024 lds
    s_waitcnt lgkmcnt(4)
    v_mfma_f32_32x32x16_bf16 v[128:143], v[204:207], v[4:7], v[128:143]
    v_add_f32 v32, v32, v32 row_shr:2 bound_ctrl:0
    s_nop 1
    v_add_f32 v32, v32, v32 row_shr:4 bound_ctrl:0
    s_nop 1
    v_add_f32 v32, v32, v32 row_shr:8 bound_ctrl:0
    s_nop 1
    v_add_f32 v32, v32, v32 row_bcast:15 row_mask:0xa
    ds_read_b128 v[8:11], v233 offset:0
    ds_read_b64_tr_b16 v[192:193], v230 offset:6144
    ds_read_b64_tr_b16 v[194:195], v230 offset:6912
    s_waitcnt lgkmcnt(5)
    v_mfma_f32_32x32x16_bf16 v[144:159], v[208:211], v[4:7], v[144:159]
    v_add_f32 v32, v32, v32 row_bcast:31 row_mask:0xc
    s_nop 0
    v_readlane_b32 s7, v32, 63
    v_mov_b32 v32, 0xbfb8aa3b
    ds_read_b64_tr_b16 v[196:197], v230 offset:6176
    ds_read_b64_tr_b16 v[198:199], v230 offset:6944
    s_add_u32 m0, s75, 81984
    s_nop 0
    buffer_load_dwordx4 v227, s[16:19], s50 offen offset:0 lds
    s_waitcnt lgkmcnt(5)
    v_mfma_f32_32x32x16_bf16 v[160:175], v[212:215], v[4:7], v[160:175]
    v_mul_f32 v32, s7, v32
    v_exp_f32 v32, v32
    s_nop 0
    v_add_f32 v32, 1.0, v32
    v_rcp_f32 v32, v32
    ds_read_b64_tr_b16 v[200:201], v230 offset:6208
    ds_read_b64_tr_b16 v[202:203], v230 offset:6976
    s_waitcnt lgkmcnt(4)
    v_mfma_f32_32x32x16_bf16 v[128:143], v[192:195], v[8:11], v[128:143]
    s_mov_b64 exec, 1
    ds_write_b32 v33, v32
    s_mov_b64 exec, -1
    ds_read_b128 v[12:15], v234 offset:0
    ds_read_b64_tr_b16 v[204:205], v230 offset:9216
    ds_read_b64_tr_b16 v[206:207], v230 offset:9984
    ds_read_b64_tr_b16 v[208:209], v230 offset:9248
    ds_read_b64_tr_b16 v[210:211], v230 offset:10016
    ds_read_b64_tr_b16 v[212:213], v230 offset:9280
    ds_read_b64_tr_b16 v[214:215], v230 offset:10048
    buffer_load_dwordx4 v228, s[16:19], s50 offen offset:1024 lds
    s_waitcnt lgkmcnt(10)
    v_mfma_f32_32x32x16_bf16 v[144:159], v[196:199], v[8:11], v[144:159]
    s_waitcnt lgkmcnt(8)
    v_mfma_f32_32x32x16_bf16 v[160:175], v[200:203], v[8:11], v[160:175]
    buffer_load_dwordx4 v229, s[16:19], s50 offen offset:2048 lds
    s_waitcnt vmcnt(5) lgkmcnt(0)
    s_barrier
    v_mfma_f32_32x32x16_bf16 v[128:143], v[204:207], v[12:15], v[128:143]
    v_and_b32 v191, 1, v223
    v_lshlrev_b32 v189, 2, v191
    ds_read_b128 v[16:19], v231 offset:40992
    ds_read_b64_tr_b16 v[192:193], v230 offset:40992
    ds_read_b64_tr_b16 v[194:195], v230 offset:41760
    v_mfma_f32_32x32x16_bf16 v[144:159], v[208:211], v[12:15], v[144:159]
    v_xor_b32 v189, v222, v189
    v_lshlrev_b32 v189, 4, v189
    ds_read_b64_tr_b16 v[196:197], v230 offset:41024
    ds_read_b64_tr_b16 v[198:199], v230 offset:41792
    s_add_u32 m0, s74, 0
    s_nop 0
    buffer_load_dwordx4 v224, s[8:11], s43 offen offset:0 lds
    v_mfma_f32_32x32x16_bf16 v[160:175], v[212:215], v[12:15], v[160:175]
    s_lshl_b32 s4, s64, 3
    v_add_u32 v191, s4, v221
    v_mul_u32_u24 v191, 3072, v191
    ds_read_b64_tr_b16 v[200:201], v230 offset:41056
    ds_read_b64_tr_b16 v[202:203], v230 offset:41824
    s_waitcnt lgkmcnt(4)
    v_mfma_f32_32x32x16_bf16 v[128:143], v[192:195], v[16:19], v[128:143]
    s_lshl_b32 s4, s68, 7
    v_add3_u32 v226, v191, v189, s4
    ds_read_b128 v[20:23], v232 offset:40992
    ds_read_b64_tr_b16 v[204:205], v230 offset:44064
    ds_read_b64_tr_b16 v[206:207], v230 offset:44832
    buffer_load_dwordx4 v225, s[8:11], s43 offen offset:1024 lds
    s_waitcnt lgkmcnt(5)
    v_mfma_f32_32x32x16_bf16 v[144:159], v[196:199], v[16:19], v[144:159]
    s_lshl_b32 s76, s64, 13
    s_mul_i32 s6, s66, 3
    ds_read_b64_tr_b16 v[208:209], v230 offset:44096
    ds_read_b64_tr_b16 v[210:211], v230 offset:44864
    s_waitcnt lgkmcnt(5)
    v_mfma_f32_32x32x16_bf16 v[160:175], v[200:203], v[16:19], v[160:175]
    s_add_u32 s94, s94, s6
    v_xor_b32 v251, s66, v245
    v_lshlrev_b32 v251, 6, v251
    ds_read_b64_tr_b16 v[212:213], v230 offset:44128
    ds_read_b64_tr_b16 v[214:215], v230 offset:44896
    s_add_u32 m0, s75, 0
    s_nop 0
    buffer_load_dwordx4 v227, s[16:19], s51 offen offset:0 lds
    s_waitcnt lgkmcnt(4)
    v_mfma_f32_32x32x16_bf16 v[128:143], v[204:207], v[20:23], v[128:143]
    v_lshl_add_u32 v251, v242, 7, v251
    v_lshl_add_u32 v251, v240, 13, v251
    ds_read_b128 v[24:27], v233 offset:40992
    ds_read_b64_tr_b16 v[192:193], v230 offset:47136
    ds_read_b64_tr_b16 v[194:195], v230 offset:47904
    s_waitcnt lgkmcnt(5)
    v_mfma_f32_32x32x16_bf16 v[144:159], v[208:211], v[20:23], v[144:159]
    v_lshl_add_u32 v251, v246, 5, v251
    v_lshl_add_u32 v251, v241, 4, v251
    v_lshl_add_u32 v235, v247, 3, v251
    ds_read_b64_tr_b16 v[196:197], v230 offset:47168
    ds_read_b64_tr_b16 v[198:199], v230 offset:47936
    s_waitcnt lgkmcnt(5)
    v_mfma_f32_32x32x16_bf16 v[160:175], v[212:215], v[20:23], v[160:175]
    v_add_u32 v235, 81984, v235
    s_lshr_b32 s7, s2, 3
    ds_read_b64_tr_b16 v[200:201], v230 offset:47200
    ds_read_b64_tr_b16 v[202:203], v230 offset:47968
    buffer_load_dwordx4 v228, s[16:19], s51 offen offset:1024 lds
    s_waitcnt lgkmcnt(4)
    v_mfma_f32_32x32x16_bf16 v[128:143], v[192:195], v[24:27], v[128:143]
    s_and_b32 s6, s2, 7
    s_and_b32 s70, s7, 3
    ds_read_b128 v[28:31], v234 offset:40992
    ds_read_b64_tr_b16 v[204:205], v230 offset:50208
    ds_read_b64_tr_b16 v[206:207], v230 offset:50976
    ds_read_b64_tr_b16 v[208:209], v230 offset:50240
    ds_read_b64_tr_b16 v[210:211], v230 offset:51008
    ds_read_b64_tr_b16 v[212:213], v230 offset:50272
    ds_read_b64_tr_b16 v[214:215], v230 offset:51040
    s_waitcnt lgkmcnt(9)
    v_mfma_f32_32x32x16_bf16 v[144:159], v[196:199], v[24:27], v[144:159]
    s_lshl_b32 s6, s6, 2
    s_add_u32 s70, s70, s6
    s_lshr_b32 s71, s7, 2
    buffer_load_dwordx4 v229, s[16:19], s51 offen offset:2048 lds
    s_waitcnt lgkmcnt(7)
    v_mfma_f32_32x32x16_bf16 v[160:175], v[200:203], v[24:27], v[160:175]
    v_lshl_add_u32 v251, v240, 2, v242
    s_lshl_b32 s77, s65, 11
    s_waitcnt vmcnt(5) lgkmcnt(0)
    s_barrier
    v_mfma_f32_32x32x16_bf16 v[128:143], v[204:207], v[28:31], v[128:143]
    v_lshl_add_u32 v251, v251, 7, s77
    v_lshl_add_u32 v251, v245, 6, v251
    ds_read_b128 v[32:35], v216 offset:0
    ds_read_b64_tr_b16 v[192:193], v220 offset:0
    ds_read_b64_tr_b16 v[194:195], v220 offset:768
    s_add_u32 m0, s74, 40992
    s_nop 0
    buffer_load_dwordx4 v224, s[8:11], s44 offen offset:0 lds
    v_mfma_f32_32x32x16_bf16 v[144:159], v[208:211], v[28:31], v[144:159]
    v_lshl_add_u32 v251, v241, 5, v251
    v_lshl_add_u32 v236, v243, 3, v251
    ds_read_b64_tr_b16 v[196:197], v220 offset:32
    ds_read_b64_tr_b16 v[198:199], v220 offset:800
    v_mfma_f32_32x32x16_bf16 v[160:175], v[212:215], v[28:31], v[160:175]
    v_xor_b32 v237, 64, v236
    s_lshl_b32 s6, s66, 13
    s_lshl_b32 s7, s71, 7
    ds_read_b64_tr_b16 v[200:201], v220 offset:64
    ds_read_b64_tr_b16 v[202:203], v220 offset:832
    buffer_load_dwordx4 v225, s[8:11], s44 offen offset:1024 lds
    s_waitcnt lgkmcnt(4)
    v_mfma_f32_32x32x16_bf16 v[128:143], v[192:195], v[32:35], v[128:143]
    s_add_u32 s6, s6, s7
    v_lshl_add_u32 v191, v221, 10, v189
    ds_read_b128 v[36:39], v217 offset:0
    ds_read_b64_tr_b16 v[204:205], v220 offset:3072
    ds_read_b64_tr_b16 v[206:207], v220 offset:3840
    s_waitcnt lgkmcnt(5)
    v_mfma_f32_32x32x16_bf16 v[144:159], v[196:199], v[32:35], v[144:159]
    v_add_u32 v238, s6, v191
    s_lshl_b32 s6, s66, 10
    ds_read_b64_tr_b16 v[208:209], v220 offset:3104
    ds_read_b64_tr_b16 v[210:211], v220 offset:3872
    s_add_u32 m0, s75, 40992
    s_nop 0
    buffer_load_dwordx4 v227, s[16:19], s52 offen offset:0 lds
    s_waitcnt lgkmcnt(5)
    v_mfma_f32_32x32x16_bf16 v[160:175], v[200:203], v[32:35], v[160:175]
    s_add_u32 s77, s77, s6
    s_mul_i32 s78, s65, 196608
    s_mul_i32 s79, s65, 163840
    ds_read_b64_tr_b16 v[212:213], v220 offset:3136
    ds_read_b64_tr_b16 v[214:215], v220 offset:3904
    s_waitcnt lgkmcnt(4)
    v_mfma_f32_32x32x16_bf16 v[128:143], v[204:207], v[36:39], v[128:143]
    s_add_u32 s79, s79, 786432
    s_lshl_b32 s80, s65, 17
    ds_read_b128 v[40:43], v218 offset:0
    ds_read_b64_tr_b16 v[192:193], v220 offset:6144
    ds_read_b64_tr_b16 v[194:195], v220 offset:6912
    buffer_load_dwordx4 v228, s[16:19], s52 offen offset:1024 lds
    s_waitcnt lgkmcnt(5)
    v_mfma_f32_32x32x16_bf16 v[144:159], v[208:211], v[36:39], v[144:159]
    s_lshr_b32 s81, s78, 4
    s_lshr_b32 s82, s79, 4
    s_lshr_b32 s83, s80, 4
    ds_read_b64_tr_b16 v[196:197], v220 offset:6176
    ds_read_b64_tr_b16 v[198:199], v220 offset:6944
    s_waitcnt lgkmcnt(5)
    v_mfma_f32_32x32x16_bf16 v[160:175], v[212:215], v[36:39], v[160:175]
    s_add_u32 s83, s83, 90112
    s_lshl_b32 s6, s67, 2
    ds_read_b64_tr_b16 v[200:201], v220 offset:6208
    ds_read_b64_tr_b16 v[202:203], v220 offset:6976
    buffer_load_dwordx4 v229, s[16:19], s52 offen offset:2048 lds
    s_waitcnt lgkmcnt(4)
    v_mfma_f32_32x32x16_bf16 v[128:143], v[192:195], v[40:43], v[128:143]
    s_add_u32 s6, s6, s65
    s_mul_i32 s6, s6, 122880
    ds_read_b128 v[44:47], v219 offset:0
    ds_read_b64_tr_b16 v[204:205], v220 offset:9216
    ds_read_b64_tr_b16 v[206:207], v220 offset:9984
    ds_read_b64_tr_b16 v[208:209], v220 offset:9248
    ds_read_b64_tr_b16 v[210:211], v220 offset:10016
    ds_read_b64_tr_b16 v[212:213], v220 offset:9280
    ds_read_b64_tr_b16 v[214:215], v220 offset:10048
    s_waitcnt lgkmcnt(9)
    v_mfma_f32_32x32x16_bf16 v[144:159], v[196:199], v[40:43], v[144:159]
    s_lshl_b32 s7, s94, 10
    s_add_u32 s6, s6, s7
    s_add_u32 s6, s6, 2097152
    s_cmp_lg_u32 s64, 1
    s_cbranch_scc1 L_gs_21
    v_and_b32 v126, 28, v249
    v_add_u32 v126, 163328, v126
    ds_read_b32 v127, v126
    s_lshr_b32 s95, s89, 3
    s_lshl_b32 s95, s95, 7
    s_add_u32 s95, s95, 1048576
    s_mov_b32 exec_hi, 0
    s_waitcnt lgkmcnt(0)
    buffer_store_dword v127, v249, s[28:31], s95 offen sc1
    s_mov_b32 exec_hi, -1
L_gs_21:
    s_waitcnt lgkmcnt(7)
    v_mfma_f32_32x32x16_bf16 v[160:175], v[200:203], v[40:43], v[160:175]
    v_add_u32 v239, s6, v188
    s_lshl_b32 s6, s70, 1
    s_waitcnt vmcnt(5) lgkmcnt(0)
    s_barrier
    v_readfirstlane_b32 s73, v248
    s_nop 0
    s_mul_i32 s72, s73, 0x9e3779b1
    s_add_u32 s72, s72, 0x7f4a7c15
    v_mov_b32 v248, s72
    v_mfma_f32_32x32x16_bf16 v[128:143], v[204:207], v[44:47], v[128:143]
    s_add_u32 s6, s6, s66
    s_mul_i32 s6, s6, 122880
    ds_read_b128 v[48:51], v231 offset:0
    ds_read_b64_tr_b16 v[192:193], v230 offset:0
    ds_read_b64_tr_b16 v[194:195], v230 offset:768
    s_add_u32 m0, s74, 81984
    s_nop 0
    buffer_load_dwordx4 v224, s[8:11], s45 offen offset:0 lds
    v_mfma_f32_32x32x16_bf16 v[144:159], v[208:211], v[44:47], v[144:159]
    s_add_u32 s6, s6, 2097152
    v_add_u32 v253, s6, v188
    ds_read_b64_tr_b16 v[196:197], v230 offset:32
    ds_read_b64_tr_b16 v[198:199], v230 offset:800
    v_mfma_f32_32x32x16_bf16 v[160:175], v[212:215], v[44:47], v[160:175]
    s_lshl_b32 s6, s67, 3
    s_add_u32 s6, s6, s68
    s_lshl_b32 s6, s6, 8
    ds_read_b64_tr_b16 v[200:201], v230 offset:64
    ds_read_b64_tr_b16 v[202:203], v230 offset:832
    buffer_load_dwordx4 v225, s[8:11], s45 offen offset:1024 lds
    s_waitcnt lgkmcnt(4)
    v_mfma_f32_32x32x16_bf16 v[128:143], v[192:195], v[48:51], v[128:143]
    s_add_u32 s85, s6, 819200
    s_add_u32 s84, s6, 753664
    ds_read_b128 v[52:55], v232 offset:0
    ds_read_b64_tr_b16 v[204:205], v230 offset:3072
    ds_read_b64_tr_b16 v[206:207], v230 offset:3840
    s_waitcnt lgkmcnt(5)
    v_mfma_f32_32x32x16_bf16 v[144:159], v[196:199], v[48:51], v[144:159]
    s_lshl_b32 s87, s68, 12
    s_add_u32 s87, s87, 720896
    ds_read_b64_tr_b16 v[208:209], v230 offset:3104
    ds_read_b64_tr_b16 v[210:211], v230 offset:3872
    s_add_u32 m0, s75, 81984
    s_nop 0
    buffer_load_dwordx4 v227, s[16:19], s53 offen offset:0 lds
    s_waitcnt lgkmcnt(5)
    v_mfma_f32_32x32x16_bf16 v[160:175], v[200:203], v[48:51], v[160:175]
    s_lshr_b32 s86, s70, 1
    s_lshl_b32 s86, s86, 11
    s_add_u32 s86, s86, 753664
    ds_read_b64_tr_b16 v[212:213], v230 offset:3136
    ds_read_b64_tr_b16 v[214:215], v230 offset:3904
    s_waitcnt lgkmcnt(4)
    v_mfma_f32_32x32x16_bf16 v[128:143], v[204:207], v[52:55], v[128:143]
    s_cmp_eq_u32 s64, 0
    s_cselect_b32 s84, s84, 2147483648
    s_cselect_b32 s85, s85, 2147483648
    s_cselect_b32 s86, s86, 2147483648
    s_cselect_b32 s87, s87, 2147483648
    v_lshlrev_b32 v250, 8, v222
    ds_read_b128 v[56:59], v233 offset:0
    ds_read_b64_tr_b16 v[192:193], v230 offset:6144
    ds_read_b64_tr_b16 v[194:195], v230 offset:6912
    buffer_load_dwordx4 v228, s[16:19], s53 offen offset:1024 lds
    s_waitcnt lgkmcnt(5)
    v_mfma_f32_32x32x16_bf16 v[144:159], v[208:211], v[52:55], v[144:159]
    v_cmp_eq_u32 vcc, v246, v240
    s_lshl_b32 s6, s66, 10
    s_add_u32 s6, s6, 156160
    ds_read_b64_tr_b16 v[196:197], v230 offset:6176
    ds_read_b64_tr_b16 v[198:199], v230 offset:6944
    s_waitcnt lgkmcnt(5)
    v_mfma_f32_32x32x16_bf16 v[160:175], v[212:215], v[52:55], v[160:175]
    v_lshl_add_u32 v251, v240, 9, s6
    v_lshl_add_u32 v251, v242, 5, v251
    ds_read_b64_tr_b16 v[200:201], v230 offset:6208
    ds_read_b64_tr_b16 v[202:203], v230 offset:6976
    buffer_load_dwordx4 v229, s[16:19], s53 offen offset:2048 lds
    s_waitcnt lgkmcnt(4)
    v_mfma_f32_32x32x16_bf16 v[128:143], v[192:195], v[56:59], v[128:143]
    v_lshl_add_u32 v251, v241, 4, v251
    v_lshl_add_u32 v251, v247, 3, v251
    ds_read_b128 v[60:63], v234 offset:0
    ds_read_b64_tr_b16 v[204:205], v230 offset:9216
    ds_read_b64_tr_b16 v[206:207], v230 offset:9984
    ds_read_b64_tr_b16 v[208:209], v230 offset:9248
    ds_read_b64_tr_b16 v[210:211], v230 offset:10016
    ds_read_b64_tr_b16 v[212:213], v230 offset:9280
    ds_read_b64_tr_b16 v[214:215], v230 offset:10048
    s_waitcnt lgkmcnt(9)
    v_mfma_f32_32x32x16_bf16 v[144:159], v[196:199], v[56:59], v[144:159]
    v_cndmask_b32 v182, v190, v251, vcc
    v_cmp_eq_u32 vcc, v241, v240
    s_mul_i32 s6, s66, 2176
    s_cmp_lg_u32 s64, 0
    s_cbranch_scc1 L_tc_22
    s_mov_b32 m0, 163072
    s_nop 0
    buffer_load_dword v252, s[36:39], s91 offen lds
L_tc_22:
    s_waitcnt lgkmcnt(7)
    v_mfma_f32_32x32x16_bf16 v[160:175], v[200:203], v[56:59], v[160:175]
    s_add_u32 s6, s6, 158208
    v_mul_u32_u24 v191, 1088, v241
    s_waitcnt vmcnt(5) lgkmcnt(0)
    s_barrier
    v_mfma_f32_32x32x16_bf16 v[128:143], v[204:207], v[60:63], v[128:143]
    v_add_u32 v191, s6, v191
    v_and_b32 v251, 15, v255
    ds_read_b128 v[64:67], v231 offset:40992
    ds_read_b64_tr_b16 v[192:193], v230 offset:40992
    ds_read_b64_tr_b16 v[194:195], v230 offset:41760
    v_mfma_f32_32x32x16_bf16 v[144:159], v[208:211], v[60:63], v[144:159]
    v_lshlrev_b32 v183, 8, v251
    v_lshl_add_u32 v251, v251, 6, v191
    ds_read_b64_tr_b16 v[196:197], v230 offset:41024
    ds_read_b64_tr_b16 v[198:199], v230 offset:41792
    s_add_u32 m0, s74, 0
    s_nop 0
    buffer_load_dwordx4 v224, s[8:11], s46 offen offset:0 lds
    v_mfma_f32_32x32x16_bf16 v[160:175], v[212:215], v[60:63], v[160:175]
    v_add_u32 v191, 1024, v191
    v_cndmask_b32 v177, v190, v251, vcc
    v_cndmask_b32 v176, v190, v191, vcc
    ds_read_b64_tr_b16 v[200:201], v230 offset:41056
    ds_read_b64_tr_b16 v[202:203], v230 offset:41824
    s_waitcnt lgkmcnt(4)
    v_mfma_f32_32x32x16_bf16 v[128:143], v[192:195], v[64:67], v[128:143]
    s_mul_i32 s6, s65, 1088
    s_lshl_b32 s7, s66, 5
    ds_read_b128 v[68:71], v232 offset:40992
    ds_read_b64_tr_b16 v[204:205], v230 offset:44064
    ds_read_b64_tr_b16 v[206:207], v230 offset:44832
    buffer_load_dwordx4 v225, s[8:11], s46 offen offset:1024 lds
    s_waitcnt lgkmcnt(5)
    v_mfma_f32_32x32x16_bf16 v[144:159], v[196:199], v[64:67], v[144:159]
    s_add_u32 s6, s6, s7
    s_add_u32 s6, s6, 158208
    ds_read_b64_tr_b16 v[208:209], v230 offset:44096
    ds_read_b64_tr_b16 v[210:211], v230 offset:44864
    s_waitcnt lgkmcnt(5)
    v_mfma_f32_32x32x16_bf16 v[160:175], v[200:203], v[64:67], v[160:175]
    v_lshl_add_u32 v191, v222, 7, s6
    v_and_b32 v251, 3, v221
    v_lshl_add_u32 v191, v251, 3, v191
    ds_read_b64_tr_b16 v[212:213], v230 offset:44128
    ds_read_b64_tr_b16 v[214:215], v230 offset:44896
    s_add_u32 m0, s75, 0
    s_nop 0
    buffer_load_dwordx4 v227, s[16:19], s54 offen offset:0 lds
    s_waitcnt lgkmcnt(4)
    v_mfma_f32_32x32x16_bf16 v[128:143], v[204:207], v[68:71], v[128:143]
    v_lshl_add_u32 v178, v240, 6, v191
    s_add_u32 s6, s6, 1024
    ds_read_b128 v[72:75], v233 offset:40992
    ds_read_b64_tr_b16 v[192:193], v230 offset:47136
    ds_read_b64_tr_b16 v[194:195], v230 offset:47904
    s_waitcnt lgkmcnt(5)
    v_mfma_f32_32x32x16_bf16 v[144:159], v[208:211], v[68:71], v[144:159]
    v_lshl_add_u32 v179, v246, 4, s6
    s_mul_i32 s6, s64, 640
    v_mul_u32_u24 v191, 5120, v240
    ds_read_b64_tr_b16 v[196:197], v230 offset:47168
    ds_read_b64_tr_b16 v[198:199], v230 offset:47936
    s_waitcnt lgkmcnt(5)
    v_mfma_f32_32x32x16_bf16 v[160:175], v[212:215], v[68:71], v[160:175]
    v_lshl_add_u32 v191, v244, 4, v191
    v_add_u32 v180, s6, v191
    ds_read_b64_tr_b16 v[200:201], v230 offset:47200
    ds_read_b64_tr_b16 v[202:203], v230 offset:47968
    buffer_load_dwordx4 v228, s[16:19], s54 offen offset:1024 lds
    s_waitcnt lgkmcnt(4)
    v_mfma_f32_32x32x16_bf16 v[128:143], v[192:195], v[72:75], v[128:143]
    v_lshrrev_b32 v251, 1, v244
    v_mul_u32_u24 v191, 5120, v251
    ds_read_b128 v[76:79], v234 offset:40992
    ds_read_b64_tr_b16 v[204:205], v230 offset:50208
    ds_read_b64_tr_b16 v[206:207], v230 offset:50976
    ds_read_b64_tr_b16 v[208:209], v230 offset:50240
    ds_read_b64_tr_b16 v[210:211], v230 offset:51008
    ds_read_b64_tr_b16 v[212:213], v230 offset:50272
    ds_read_b64_tr_b16 v[214:215], v230 offset:51040
    s_waitcnt lgkmcnt(9)
    v_mfma_f32_32x32x16_bf16 v[144:159], v[196:199], v[72:75], v[144:159]
    v_lshl_add_u32 v191, v246, 4, v191
    s_add_u32 s6, s6, 512
    v_add_u32 v181, s6, v191
    buffer_load_dwordx4 v229, s[16:19], s54 offen offset:2048 lds
    s_waitcnt lgkmcnt(7)
    v_mfma_f32_32x32x16_bf16 v[160:175], v[200:203], v[72:75], v[160:175]
    s_mul_i32 s88, s68, 81920
    s_add_u32 s88, s88, 65536
    s_waitcnt vmcnt(5) lgkmcnt(0)
    s_barrier
    v_mfma_f32_32x32x16_bf16 v[128:143], v[204:207], v[76:79], v[128:143]
    v_lshlrev_b32 v191, 4, v246
    v_mov_b32 v245, 0x3f80
    ds_read_b128 v[80:83], v216 offset:0
    ds_read_b64_tr_b16 v[192:193], v220 offset:0
    ds_read_b64_tr_b16 v[194:195], v220 offset:768
    v_mfma_f32_32x32x16_bf16 v[144:159], v[208:211], v[76:79], v[144:159]
    v_lshlrev_b32 v191, v191, v245
    v_cmp_eq_u32 vcc, 0, v251
    ds_read_b64_tr_b16 v[196:197], v220 offset:32
    ds_read_b64_tr_b16 v[198:199], v220 offset:800
    s_add_u32 m0, s74, 40992
    s_nop 0
    buffer_load_dwordx4 v224, s[8:11], s47 offen offset:0 lds
    v_mfma_f32_32x32x16_bf16 v[160:175], v[212:215], v[76:79], v[160:175]
    v_cndmask_b32 v184, 0, v191, vcc
    v_cmp_eq_u32 vcc, 1, v251
    s_nop 1
    v_cndmask_b32 v185, 0, v191, vcc
    ds_read_b64_tr_b16 v[200:201], v220 offset:64
    ds_read_b64_tr_b16 v[202:203], v220 offset:832
    s_waitcnt lgkmcnt(4)
    v_mfma_f32_32x32x16_bf16 v[128:143], v[192:195], v[80:83], v[128:143]
    v_cmp_eq_u32 vcc, 2, v251
    s_nop 1
    v_cndmask_b32 v186, 0, v191, vcc
    ds_read_b128 v[84:87], v217 offset:0
    ds_read_b64_tr_b16 v[204:205], v220 offset:3072
    ds_read_b64_tr_b16 v[206:207], v220 offset:3840
    buffer_load_dwordx4 v225, s[8:11], s47 offen offset:1024 lds
    s_waitcnt lgkmcnt(5)
    v_mfma_f32_32x32x16_bf16 v[144:159], v[196:199], v[80:83], v[144:159]
    v_cmp_eq_u32 vcc, 3, v251
    s_nop 1
    v_cndmask_b32 v187, 0, v191, vcc
    ds_read_b64_tr_b16 v[208:209], v220 offset:3104
    ds_read_b64_tr_b16 v[210:211], v220 offset:3872
    s_waitcnt lgkmcnt(5)
    v_mfma_f32_32x32x16_bf16 v[160:175], v[200:203], v[80:83], v[160:175]
    s_lshl_b32 s90, s68, 1
    s_add_u32 s90, s90, s66
    s_sub_u32 s90, 88, s90
    ds_read_b64_tr_b16 v[212:213], v220 offset:3136
    ds_read_b64_tr_b16 v[214:215], v220 offset:3904
    s_add_u32 m0, s75, 40992
    s_nop 0
    buffer_load_dwordx4 v227, s[16:19], s55 offen offset:0 lds
    s_waitcnt lgkmcnt(4)
    v_mfma_f32_32x32x16_bf16 v[128:143], v[204:207], v[84:87], v[128:143]
    s_lshl_b32 s90, s90, 10
    ds_read_b128 v[88:91], v218 offset:0
    ds_read_b64_tr_b16 v[192:193], v220 offset:6144
    ds_read_b64_tr_b16 v[194:195], v220 offset:6912
    s_waitcnt lgkmcnt(5)
    v_mfma_f32_32x32x16_bf16 v[144:159], v[208:211], v[84:87], v[144:159]
    ds_read_b64_tr_b16 v[196:197], v220 offset:6176
    ds_read_b64_tr_b16 v[198:199], v220 offset:6944
    s_waitcnt lgkmcnt(5)
    v_mfma_f32_32x32x16_bf16 v[160:175], v[212:215], v[84:87], v[160:175]
    ds_read_b64_tr_b16 v[200:201], v220 offset:6208
    ds_read_b64_tr_b16 v[202:203], v220 offset:6976
    buffer_load_dwordx4 v228, s[16:19], s55 offen offset:1024 lds
    s_waitcnt lgkmcnt(4)
    v_mfma_f32_32x32x16_bf16 v[128:143], v[192:195], v[88:91], v[128:143]
    ds_read_b128 v[92:95], v219 offset:0
    ds_read_b64_tr_b16 v[204:205], v220 offset:9216
    ds_read_b64_tr_b16 v[206:207], v220 offset:9984
    ds_read_b64_tr_b16 v[208:209], v220 offset:9248
    ds_read_b64_tr_b16 v[210:211], v220 offset:10016
    ds_read_b64_tr_b16 v[212:213], v220 offset:9280
    ds_read_b64_tr_b16 v[214:215], v220 offset:10048
    s_waitcnt lgkmcnt(9)
    v_mfma_f32_32x32x16_bf16 v[144:159], v[196:199], v[88:91], v[144:159]
    buffer_load_dwordx4 v229, s[16:19], s55 offen offset:2048 lds
    s_waitcnt lgkmcnt(7)
    v_mfma_f32_32x32x16_bf16 v[160:175], v[200:203], v[88:91], v[160:175]
    s_waitcnt vmcnt(5) lgkmcnt(0)
    s_barrier
    v_add_u32 v247, s79, v238
    v_add_u32 v252, s80, v238
    v_add_u32 v238, s78, v238
    v_add_u32 v253, s81, v253
    s_sub_u32 s40, s82, s81
    s_sub_u32 s48, s83, s82
    s_and_b32 s6, s70, 3
    s_lshl_b32 s78, s6, 15
    s_lshl_b32 s79, s6, 14
    s_and_b32 s80, s79, 0x4000
    s_lshr_b32 s81, s78, 4
    s_lshr_b32 s82, s79, 4
    s_lshr_b32 s83, s80, 4
    v_mfma_f32_32x32x16_bf16 v[128:143], v[204:207], v[92:95], v[128:143]
    ds_read_b128 v[96:99], v231 offset:0
    ds_read_b64_tr_b16 v[192:193], v230 offset:0
    ds_read_b64_tr_b16 v[194:195], v230 offset:768
    s_add_u32 m0, s76, 81984
    s_nop 0
    buffer_load_dwordx4 v226, s[12:15], s56 offen offset:0 lds
    v_mfma_f32_32x32x16_bf16 v[144:159], v[208:211], v[92:95], v[144:159]
    ds_read_b64_tr_b16 v[196:197], v230 offset:32
    ds_read_b64_tr_b16 v[198:199], v230 offset:800
    v_mfma_f32_32x32x16_bf16 v[160:175], v[212:215], v[92:95], v[160:175]
    ds_read_b64_tr_b16 v[200:201], v230 offset:64
    ds_read_b64_tr_b16 v[202:203], v230 offset:832
    buffer_load_dwordx4 v226, s[12:15], s57 offen offset:1024 lds
    s_waitcnt lgkmcnt(4)
    v_mfma_f32_32x32x16_bf16 v[128:143], v[192:195], v[96:99], v[128:143]
    ds_read_b128 v[100:103], v232 offset:0
    ds_read_b64_tr_b16 v[204:205], v230 offset:3072
    ds_read_b64_tr_b16 v[206:207], v230 offset:3840
    buffer_load_dwordx4 v226, s[12:15], s58 offen offset:2048 lds
    s_waitcnt lgkmcnt(5)
    v_mfma_f32_32x32x16_bf16 v[144:159], v[196:199], v[96:99], v[144:159]
    ds_read_b64_tr_b16 v[208:209], v230 offset:3104
    ds_read_b64_tr_b16 v[210:211], v230 offset:3872
    s_waitcnt lgkmcnt(5)
    v_mfma_f32_32x32x16_bf16 v[160:175], v[200:203], v[96:99], v[160:175]
    ds_read_b64_tr_b16 v[212:213], v230 offset:3136
    ds_read_b64_tr_b16 v[214:215], v230 offset:3904
    buffer_load_dwordx4 v226, s[12:15], s59 offen offset:3072 lds
    s_waitcnt lgkmcnt(4)
    v_mfma_f32_32x32x16_bf16 v[128:143], v[204:207], v[100:103], v[128:143]
    ds_read_b128 v[104:107], v233 offset:0
    ds_read_b64_tr_b16 v[192:193], v230 offset:6144
    ds_read_b64_tr_b16 v[194:195], v230 offset:6912
    s_add_u32 m0, s76, 86080
    s_nop 0
    buffer_load_dwordx4 v226, s[12:15], s60 offen offset:0 lds
    s_waitcnt lgkmcnt(5)
    v_mfma_f32_32x32x16_bf16 v[144:159], v[208:211], v[100:103], v[144:159]
    ds_read_b64_tr_b16 v[196:197], v230 offset:6176
    ds_read_b64_tr_b16 v[198:199], v230 offset:6944
    s_waitcnt lgkmcnt(5)
    v_mfma_f32_32x32x16_bf16 v[160:175], v[212:215], v[100:103], v[160:175]
    ds_read_b64_tr_b16 v[200:201], v230 offset:6208
    ds_read_b64_tr_b16 v[202:203], v230 offset:6976
    buffer_load_dwordx4 v226, s[12:15], s61 offen offset:1024 lds
    s_waitcnt lgkmcnt(4)
    v_mfma_f32_32x32x16_bf16 v[128:143], v[192:195], v[104:107], v[128:143]
    ds_read_b128 v[108:111], v234 offset:0
    ds_read_b64_tr_b16 v[204:205], v230 offset:9216
    ds_read_b64_tr_b16 v[206:207], v230 offset:9984
    ds_read_b64_tr_b16 v[208:209], v230 offset:9248
    ds_read_b64_tr_b16 v[210:211], v230 offset:10016
    ds_read_b64_tr_b16 v[212:213], v230 offset:9280
    ds_read_b64_tr_b16 v[214:215], v230 offset:10048
    buffer_load_dwordx4 v226, s[12:15], s62 offen offset:2048 lds
    s_waitcnt lgkmcnt(9)
    v_mfma_f32_32x32x16_bf16 v[144:159], v[196:199], v[104:107], v[144:159]
    s_waitcnt lgkmcnt(7)
    v_mfma_f32_32x32x16_bf16 v[160:175], v[200:203], v[104:107], v[160:175]
    buffer_load_dwordx4 v226, s[12:15], s63 offen offset:3072 lds
    s_waitcnt vmcnt(8) lgkmcnt(0)
    s_barrier
    v_mfma_f32_32x32x16_bf16 v[128:143], v[204:207], v[108:111], v[128:143]
    ds_read_b128 v[112:115], v231 offset:40992
    ds_read_b64_tr_b16 v[192:193], v230 offset:40992
    ds_read_b64_tr_b16 v[194:195], v230 offset:41760
    v_mfma_f32_32x32x16_bf16 v[144:159], v[208:211], v[108:111], v[144:159]
    ds_read_b64_tr_b16 v[196:197], v230 offset:41024
    ds_read_b64_tr_b16 v[198:199], v230 offset:41792
    s_add_u32 m0, s77, 0
    s_xor_b32 s95, s78, 0
    buffer_load_dwordx4 v238, s[20:23], s95 offen offset:0 lds
    v_mfma_f32_32x32x16_bf16 v[160:175], v[212:215], v[108:111], v[160:175]
    ds_read_b64_tr_b16 v[200:201], v230 offset:41056
    ds_read_b64_tr_b16 v[202:203], v230 offset:41824
    s_waitcnt lgkmcnt(4)
    v_mfma_f32_32x32x16_bf16 v[128:143], v[192:195], v[112:115], v[128:143]
    ds_read_b128 v[116:119], v232 offset:40992
    ds_read_b64_tr_b16 v[204:205], v230 offset:44064
    ds_read_b64_tr_b16 v[206:207], v230 offset:44832
    s_add_u32 m0, s77, 8192
    s_xor_b32 s95, s78, 16384
    buffer_load_dwordx4 v238, s[20:23], s95 offen offset:0 lds
    s_waitcnt lgkmcnt(5)
    v_mfma_f32_32x32x16_bf16 v[144:159], v[196:199], v[112:115], v[144:159]
    ds_read_b64_tr_b16 v[208:209], v230 offset:44096
    ds_read_b64_tr_b16 v[210:211], v230 offset:44864
    s_waitcnt lgkmcnt(5)
    v_mfma_f32_32x32x16_bf16 v[160:175], v[200:203], v[112:115], v[160:175]
    ds_read_b64_tr_b16 v[212:213], v230 offset:44128
    ds_read_b64_tr_b16 v[214:215], v230 offset:44896
    s_waitcnt lgkmcnt(4)
    v_mfma_f32_32x32x16_bf16 v[128:143], v[204:207], v[116:119], v[128:143]
    ds_read_b128 v[120:123], v233 offset:40992
    ds_read_b64_tr_b16 v[192:193], v230 offset:47136
    ds_read_b64_tr_b16 v[194:195], v230 offset:47904
    s_add_u32 m0, s77, 16384
    s_xor_b32 s95, s78, 32768
    buffer_load_dwordx4 v238, s[20:23], s95 offen offset:0 lds
    s_waitcnt lgkmcnt(5)
    v_mfma_f32_32x32x16_bf16 v[144:159], v[208:211], v[116:119], v[144:159]
    ds_read_b64_tr_b16 v[196:197], v230 offset:47168
    ds_read_b64_tr_b16 v[198:199], v230 offset:47936
    s_waitcnt lgkmcnt(5)
    v_mfma_f32_32x32x16_bf16 v[160:175], v[212:215], v[116:119], v[160:175]
    ds_read_b64_tr_b16 v[200:201], v230 offset:47200
    ds_read_b64_tr_b16 v[202:203], v230 offset:47968
    s_add_u32 m0, s77, 24576
    s_xor_b32 s95, s78, 49152
    buffer_load_dwordx4 v238, s[20:23], s95 offen offset:0 lds
    s_waitcnt lgkmcnt(4)
    v_mfma_f32_32x32x16_bf16 v[128:143], v[192:195], v[120:123], v[128:143]
    ds_read_b128 v[124:127], v234 offset:40992
    ds_read_b64_tr_b16 v[204:205], v230 offset:50208
    ds_read_b64_tr_b16 v[206:207], v230 offset:50976
    ds_read_b64_tr_b16 v[208:209], v230 offset:50240
    ds_read_b64_tr_b16 v[210:211], v230 offset:51008
    ds_read_b64_tr_b16 v[212:213], v230 offset:50272
    ds_read_b64_tr_b16 v[214:215], v230 offset:51040
    s_waitcnt lgkmcnt(9)
    v_mfma_f32_32x32x16_bf16 v[144:159], v[196:199], v[120:123], v[144:159]
    s_waitcnt lgkmcnt(7)
    v_mfma_f32_32x32x16_bf16 v[160:175], v[200:203], v[120:123], v[160:175]
    s_add_u32 m0, s77, 32768
    s_xor_b32 s95, s78, 65536
    buffer_load_dwordx4 v238, s[20:23], s95 offen offset:0 lds
    s_waitcnt lgkmcnt(4)
    v_mfma_f32_32x32x16_bf16 v[128:143], v[204:207], v[124:127], v[128:143]
    s_waitcnt lgkmcnt(2)
    v_mfma_f32_32x32x16_bf16 v[144:159], v[208:211], v[124:127], v[144:159]
    s_add_u32 m0, s77, 147968
    s_xor_b32 s95, s78, 98304
    buffer_load_dwordx4 v247, s[20:23], s95 offen offset:0 lds
    s_waitcnt lgkmcnt(0)
    v_mfma_f32_32x32x16_bf16 v[160:175], v[212:215], v[124:127], v[160:175]
    s_waitcnt vmcnt(6)
    s_barrier
    s_nop 2
    v_mul_f32 v128, v128, v136
    v_mul_f32 v129, v129, v137
    v_mul_f32 v130, v130, v138
    v_mul_f32 v131, v131, v139
    v_mul_f32 v132, v132, v140
    v_mul_f32 v133, v133, v141
    v_mul_f32 v134, v134, v142
    v_mul_f32 v135, v135, v143
    v_cvt_pk_bf16_f32 v216, v128, v129
    v_cvt_pk_bf16_f32 v217, v130, v131
    v_cvt_pk_bf16_f32 v218, v132, v133
    v_cvt_pk_bf16_f32 v219, v134, v135
    buffer_store_dwordx4 v[216:219], v239, s[28:31], 0 offen offset:0 sc1
    v_mul_f32 v144, v144, v152
    v_mul_f32 v145, v145, v153
    v_mul_f32 v146, v146, v154
    v_mul_f32 v147, v147, v155
    v_mul_f32 v148, v148, v156
    v_mul_f32 v149, v149, v157
    v_mul_f32 v150, v150, v158
    v_mul_f32 v151, v151, v159
    v_cvt_pk_bf16_f32 v220, v144, v145
    v_cvt_pk_bf16_f32 v221, v146, v147
    v_cvt_pk_bf16_f32 v222, v148, v149
    v_cvt_pk_bf16_f32 v223, v150, v151
    buffer_store_dwordx4 v[220:223], v239, s[28:31], 0 offen offset:1024 sc1
    v_mul_f32 v160, v160, v168
    v_mul_f32 v161, v161, v169
    v_mul_f32 v162, v162, v170
    v_mul_f32 v163, v163, v171
    v_mul_f32 v164, v164, v172
    v_mul_f32 v165, v165, v173
    v_mul_f32 v166, v166, v174
    v_mul_f32 v167, v167, v175
    v_cvt_pk_bf16_f32 v188, v160, v161
    v_cvt_pk_bf16_f32 v189, v162, v163
    v_cvt_pk_bf16_f32 v190, v164, v165
    v_cvt_pk_bf16_f32 v191, v166, v167
    buffer_store_dwordx4 v[188:191], v239, s[28:31], 0 offen offset:2048 sc1
    ds_read_b64_tr_b16 v[192:193], v235 offset:0
    ds_read_b64_tr_b16 v[194:195], v235 offset:512
    ds_read_b64_tr_b16 v[196:197], v235 offset:16384
    ds_read_b64_tr_b16 v[198:199], v235 offset:16896
    ds_read_b64_tr_b16 v[200:201], v235 offset:32768
    ds_read_b64_tr_b16 v[202:203], v235 offset:33280
    s_waitcnt lgkmcnt(4)
    v_mfma_f32_32x32x16_bf16 v[128:143], v[192:195], v[0:3], 0
    ds_read_b64_tr_b16 v[204:205], v235 offset:49152
    ds_read_b64_tr_b16 v[206:207], v235 offset:49664
    s_waitcnt lgkmcnt(4)
    v_mfma_f32_32x32x16_bf16 v[128:143], v[196:199], v[4:7], v[128:143]
    ds_read_b64_tr_b16 v[192:193], v235 offset:1024
    ds_read_b64_tr_b16 v[194:195], v235 offset:1536
    s_waitcnt lgkmcnt(4)
    v_mfma_f32_32x32x16_bf16 v[128:143], v[200:203], v[8:11], v[128:143]
    ds_read_b64_tr_b16 v[196:197], v235 offset:17408
    ds_read_b64_tr_b16 v[198:199], v235 offset:17920
    s_waitcnt lgkmcnt(4)
    v_mfma_f32_32x32x16_bf16 v[128:143], v[204:207], v[12:15], v[128:143]
    ds_read_b64_tr_b16 v[200:201], v235 offset:33792
    ds_read_b64_tr_b16 v[202:203], v235 offset:34304
    s_waitcnt lgkmcnt(4)
    v_mfma_f32_32x32x16_bf16 v[128:143], v[192:195], v[16:19], v[128:143]
    ds_read_b64_tr_b16 v[204:205], v235 offset:50176
    ds_read_b64_tr_b16 v[206:207], v235 offset:50688
    s_waitcnt lgkmcnt(4)
    v_mfma_f32_32x32x16_bf16 v[128:143], v[196:199], v[20:23], v[128:143]
    ds_read_b64_tr_b16 v[192:193], v235 offset:2048
    ds_read_b64_tr_b16 v[194:195], v235 offset:2560
    s_waitcnt lgkmcnt(4)
    v_mfma_f32_32x32x16_bf16 v[128:143], v[200:203], v[24:27], v[128:143]
    ds_read_b64_tr_b16 v[196:197], v235 offset:18432
    ds_read_b64_tr_b16 v[198:199], v235 offset:18944
    s_waitcnt lgkmcnt(4)
    v_mfma_f32_32x32x16_bf16 v[128:143], v[204:207], v[28:31], v[128:143]
    ds_read_b64_tr_b16 v[200:201], v235 offset:34816
    ds_read_b64_tr_b16 v[202:203], v235 offset:35328
    s_waitcnt lgkmcnt(4)
    v_mfma_f32_32x32x16_bf16 v[128:143], v[192:195], v[32:35], v[128:143]
    ds_read_b64_tr_b16 v[204:205], v235 offset:51200
    ds_read_b64_tr_b16 v[206:207], v235 offset:51712
    s_add_u32 m0, s77, 40960
    s_xor_b32 s95, s78, 81920
    buffer_load_dwordx4 v238, s[20:23], s95 offen offset:0 lds
    s_waitcnt lgkmcnt(4)
    v_mfma_f32_32x32x16_bf16 v[128:143], v[196:199], v[36:39], v[128:143]
    ds_read_b64_tr_b16 v[192:193], v235 offset:3072
    ds_read_b64_tr_b16 v[194:195], v235 offset:3584
    s_waitcnt lgkmcnt(4)
    v_mfma_f32_32x32x16_bf16 v[128:143], v[200:203], v[40:43], v[128:143]
    ds_read_b64_tr_b16 v[196:197], v235 offset:19456
    ds_read_b64_tr_b16 v[198:199], v235 offset:19968
    s_add_u32 m0, s77, 49152
    s_xor_b32 s95, s78, 98304
    buffer_load_dwordx4 v238, s[20:23], s95 offen offset:0 lds
    s_waitcnt vmcnt(6)
    s_barrier
    s_waitcnt lgkmcnt(4)
    v_mfma_f32_32x32x16_bf16 v[128:143], v[204:207], v[44:47], v[128:143]
    ds_read_b64_tr_b16 v[200:201], v235 offset:35840
    ds_read_b64_tr_b16 v[202:203], v235 offset:36352
    ds_read_b64_tr_b16 v[0:1], v236 offset:0
    ds_read_b64_tr_b16 v[2:3], v236 offset:1024
    ds_read_b64_tr_b16 v[4:5], v237 offset:0
    ds_read_b64_tr_b16 v[6:7], v237 offset:1024
    s_waitcnt lgkmcnt(8)
    v_mfma_f32_32x32x16_bf16 v[128:143], v[192:195], v[48:51], v[128:143]
    ds_read_b64_tr_b16 v[204:205], v235 offset:52224
    ds_read_b64_tr_b16 v[206:207], v235 offset:52736
    s_add_u32 m0, s77, 57344
    s_xor_b32 s95, s78, 114688
    buffer_load_dwordx4 v238, s[20:23], s95 offen offset:0 lds
    ds_read_b64_tr_b16 v[8:9], v236 offset:8192
    ds_read_b64_tr_b16 v[10:11], v236 offset:9216
    ds_read_b64_tr_b16 v[12:13], v237 offset:8192
    ds_read_b64_tr_b16 v[14:15], v237 offset:9216
    s_waitcnt lgkmcnt(12)
    v_mfma_f32_32x32x16_bf16 v[128:143], v[196:199], v[52:55], v[128:143]
    ds_read_b64_tr_b16 v[192:193], v235 offset:4096
    ds_read_b64_tr_b16 v[194:195], v235 offset:4608
    ds_read_b64_tr_b16 v[16:17], v236 offset:16384
    ds_read_b64_tr_b16 v[18:19], v236 offset:17408
    ds_read_b64_tr_b16 v[20:21], v237 offset:16384
    ds_read_b64_tr_b16 v[22:23], v237 offset:17408
    s_waitcnt lgkmcnt(15)
    v_mfma_f32_32x32x16_bf16 v[128:143], v[200:203], v[56:59], v[128:143]
    ds_read_b64_tr_b16 v[196:197], v235 offset:20480
    ds_read_b64_tr_b16 v[198:199], v235 offset:20992
    s_add_u32 m0, s77, 65536
    s_xor_b32 s95, s79, 131072
    buffer_load_dwordx4 v238, s[20:23], s95 offen offset:0 lds
    ds_read_b64_tr_b16 v[24:25], v236 offset:24576
    ds_read_b64_tr_b16 v[26:27], v236 offset:25600
    ds_read_b64_tr_b16 v[28:29], v237 offset:24576
    ds_read_b64_tr_b16 v[30:31], v237 offset:25600
    s_waitcnt lgkmcnt(15)
    v_mfma_f32_32x32x16_bf16 v[128:143], v[204:207], v[60:63], v[128:143]
    ds_read_b64_tr_b16 v[200:201], v235 offset:36864
    ds_read_b64_tr_b16 v[202:203], v235 offset:37376
    ds_read_b64_tr_b16 v[32:33], v236 offset:32768
    ds_read_b64_tr_b16 v[34:35], v236 offset:33792
    ds_read_b64_tr_b16 v[36:37], v237 offset:32768
    ds_read_b64_tr_b16 v[38:39], v237 offset:33792
    s_waitcnt lgkmcnt(15)
    v_mfma_f32_32x32x16_bf16 v[128:143], v[192:195], v[64:67], v[128:143]
    ds_read_b64_tr_b16 v[204:205], v235 offset:53248
    ds_read_b64_tr_b16 v[206:207], v235 offset:53760
    s_add_u32 m0, s77, 73728
    s_xor_b32 s95, s79, 147456
    buffer_load_dwordx4 v238, s[20:23], s95 offen offset:0 lds
    s_waitcnt lgkmcnt(12)
    v_mfma_f32_32x32x16_bf16 v[128:143], v[196:199], v[68:71], v[128:143]
    ds_read_b64_tr_b16 v[192:193], v235 offset:5120
    ds_read_b64_tr_b16 v[194:195], v235 offset:5632
    s_waitcnt lgkmcnt(8)
    v_mfma_f32_32x32x16_bf16 v[128:143], v[200:203], v[72:75], v[128:143]
    ds_read_b64_tr_b16 v[196:197], v235 offset:21504
    ds_read_b64_tr_b16 v[198:199], v235 offset:22016
    s_waitcnt lgkmcnt(4)
    v_mfma_f32_32x32x16_bf16 v[128:143], v[204:207], v[76:79], v[128:143]
    ds_read_b64_tr_b16 v[200:201], v235 offset:37888
    ds_read_b64_tr_b16 v[202:203], v235 offset:38400
    s_waitcnt lgkmcnt(4)
    v_mfma_f32_32x32x16_bf16 v[128:143], v[192:195], v[80:83], v[128:143]
    ds_read_b64_tr_b16 v[204:205], v235 offset:54272
    ds_read_b64_tr_b16 v[206:207], v235 offset:54784
    ds_read_b64_tr_b16 v[216:217], v182 offset:0
    ds_read_b64_tr_b16 v[218:219], v182 offset:128
    ds_read_b64_tr_b16 v[220:221], v182 offset:256
    ds_read_b64_tr_b16 v[222:223], v182 offset:384
    s_waitcnt lgkmcnt(8)
    v_mfma_f32_32x32x16_bf16 v[128:143], v[196:199], v[84:87], v[128:143]
    ds_read_b64_tr_b16 v[192:193], v235 offset:6144
    ds_read_b64_tr_b16 v[194:195], v235 offset:6656
    s_waitcnt lgkmcnt(8)
    v_mfma_f32_32x32x16_bf16 v[128:143], v[200:203], v[88:91], v[128:143]
    ds_read_b64_tr_b16 v[196:197], v235 offset:22528
    ds_read_b64_tr_b16 v[198:199], v235 offset:23040
    s_waitcnt lgkmcnt(8)
    v_mfma_f32_32x32x16_bf16 v[128:143], v[204:207], v[92:95], v[128:143]
    ds_read_b64_tr_b16 v[200:201], v235 offset:38912
    ds_read_b64_tr_b16 v[202:203], v235 offset:39424
    s_waitcnt lgkmcnt(4)
    v_mfma_f32_32x32x16_bf16 v[128:143], v[192:195], v[96:99], v[128:143]
    ds_read_b64_tr_b16 v[204:205], v235 offset:55296
    ds_read_b64_tr_b16 v[206:207], v235 offset:55808
    s_waitcnt vmcnt(0) lgkmcnt(0)
    s_barrier
    v_mfma_f32_32x32x16_bf16 v[128:143], v[196:199], v[100:103], v[128:143]
    ds_read_b64_tr_b16 v[192:193], v235 offset:7168
    ds_read_b64_tr_b16 v[194:195], v235 offset:7680
    ds_read_b64_tr_b16 v[40:41], v236 offset:40960
    ds_read_b64_tr_b16 v[42:43], v236 offset:41984
    ds_read_b64_tr_b16 v[44:45], v237 offset:40960
    ds_read_b64_tr_b16 v[46:47], v237 offset:41984
    s_add_u32 m0, s77, 0
    s_xor_b32 s95, s78, 114688
    buffer_load_dwordx4 v247, s[20:23], s95 offen offset:0 lds
    v_mfma_f32_32x32x16_bf16 v[128:143], v[200:203], v[104:107], v[128:143]
    ds_read_b64_tr_b16 v[196:197], v235 offset:23552
    ds_read_b64_tr_b16 v[198:199], v235 offset:24064
    ds_read_b64_tr_b16 v[48:49], v236 offset:49152
    ds_read_b64_tr_b16 v[50:51], v236 offset:50176
    ds_read_b64_tr_b16 v[52:53], v237 offset:49152
    ds_read_b64_tr_b16 v[54:55], v237 offset:50176
    s_add_u32 m0, s77, 8192
    s_xor_b32 s95, s80, 131072
    buffer_load_dwordx4 v247, s[20:23], s95 offen offset:0 lds
    v_mfma_f32_32x32x16_bf16 v[128:143], v[204:207], v[108:111], v[128:143]
    ds_read_b64_tr_b16 v[200:201], v235 offset:39936
    ds_read_b64_tr_b16 v[202:203], v235 offset:40448
    s_cmp_lg_u32 s64, 0
    s_cbranch_scc1 L_pi_23
    s_add_u32 s97, s87, 0
    buffer_load_dword v251, v183, s[28:31], s97 offen sc1
L_pi_23:
    ds_read_b64_tr_b16 v[56:57], v236 offset:57344
    ds_read_b64_tr_b16 v[58:59], v236 offset:58368
    ds_read_b64_tr_b16 v[60:61], v237 offset:57344
    ds_read_b64_tr_b16 v[62:63], v237 offset:58368
    s_add_u32 m0, s77, 16384
    s_xor_b32 s95, s80, 147456
    buffer_load_dwordx4 v247, s[20:23], s95 offen offset:0 lds
    s_waitcnt lgkmcnt(15)
    v_mfma_f32_32x32x16_bf16 v[128:143], v[192:195], v[112:115], v[128:143]
    ds_read_b64_tr_b16 v[204:205], v235 offset:56320
    ds_read_b64_tr_b16 v[206:207], v235 offset:56832
    v_add_u32 v236, 65536, v236
    v_add_u32 v237, 65536, v237
    ds_read_b64_tr_b16 v[64:65], v236 offset:0
    ds_read_b64_tr_b16 v[66:67], v236 offset:1024
    ds_read_b64_tr_b16 v[68:69], v237 offset:0
    ds_read_b64_tr_b16 v[70:71], v237 offset:1024
    s_add_u32 m0, s77, 24576
    s_xor_b32 s95, s78, 0
    buffer_load_dwordx4 v252, s[24:27], s95 offen offset:0 lds
    s_waitcnt lgkmcnt(15)
    v_mfma_f32_32x32x16_bf16 v[128:143], v[196:199], v[116:119], v[128:143]
    ds_read_b64_tr_b16 v[72:73], v236 offset:8192
    ds_read_b64_tr_b16 v[74:75], v236 offset:9216
    ds_read_b64_tr_b16 v[76:77], v237 offset:8192
    ds_read_b64_tr_b16 v[78:79], v237 offset:9216
    s_add_u32 m0, s77, 32768
    s_xor_b32 s95, s78, 16384
    buffer_load_dwordx4 v252, s[24:27], s95 offen offset:0 lds
    s_waitcnt lgkmcnt(14)
    v_mfma_f32_32x32x16_bf16 v[128:143], v[200:203], v[120:123], v[128:143]
    s_waitcnt lgkmcnt(8)
    v_mfma_f32_32x32x16_bf16 v[128:143], v[204:207], v[124:127], v[128:143]
    s_waitcnt lgkmcnt(0)
    s_cmp_lg_u32 s64, 0
    s_cbranch_scc1 L_pc_24
    s_waitcnt vmcnt(3)
    v_cmp_ne_u32 vcc, s72, v251
    s_mov_b32 s96, 0
    s_cbranch_vccz L_pc_24
L_pl_25:
    s_waitcnt vmcnt(3)
    buffer_load_dword v251, v183, s[28:31], s97 offen sc1
    s_waitcnt vmcnt(0)
    s_waitcnt vmcnt(3)
    v_cmp_ne_u32 vcc, s72, v251
    s_add_u32 s96, s96, 1
    s_cmp_gt_u32 s96, 200000
    s_cbranch_scc1 L_pc_24
    s_cbranch_vccz L_pc_24
    s_sleep 1
    s_branch L_pl_25
L_pc_24:
    s_barrier
    buffer_store_dword v248, v249, s[28:31], s84 offen sc1
    s_nop 6
    v_cvt_pk_bf16_f32 v208, v128, v129
    v_cvt_pk_bf16_f32 v209, v130, v131
    v_cvt_pk_bf16_f32 v210, v132, v133
    v_cvt_pk_bf16_f32 v211, v134, v135
    v_cvt_pk_bf16_f32 v212, v136, v137
    buffer_load_dwordx4 v[120:123], v181, s[28:31], s88 offen sc1
    v_cvt_pk_bf16_f32 v213, v138, v139
    v_cvt_pk_bf16_f32 v214, v140, v141
    v_cvt_pk_bf16_f32 v215, v142, v143
    v_mfma_f32_32x32x16_bf16 v[128:143], v[216:219], v[208:211], 0
    s_nop 0
    v_mfma_f32_32x32x16_bf16 v[128:143], v[220:223], v[212:215], v[128:143]
    s_nop 11
    v_max3_f32 v240, v128, v129, v130
    v_min3_f32 v241, v128, v129, v130
    v_max3_f32 v240, v240, v131, v132
    v_min3_f32 v241, v241, v131, v132
    v_max3_f32 v240, v240, v133, v134
    v_min3_f32 v241, v241, v133, v134
    s_add_u32 s3, s67, 0
    s_and_b32 s3, s3, 7
    s_mul_i32 s3, s3, 10240
    s_add_u32 s3, s3, s88
    buffer_load_dwordx4 v[88:91], v180, s[28:31], s3 offen sc1
    v_max3_f32 v240, v240, v135, v136
    v_min3_f32 v241, v241, v135, v136
    v_max3_f32 v240, v240, v137, v138
    v_min3_f32 v241, v241, v137, v138
    v_max3_f32 v240, v240, v139, v140
    v_min3_f32 v241, v241, v139, v140
    v_max3_f32 v240, v240, v141, v142
    v_min3_f32 v241, v241, v141, v142
    v_max_f32 v240, v240, v143
    v_min_f32 v241, v241, v143
    v_mul_f32 v240, 0xbfb8aa3b, v240
    s_add_u32 s3, s67, 1
    s_and_b32 s3, s3, 7
    s_mul_i32 s3, s3, 10240
    s_add_u32 s3, s3, s88
    buffer_load_dwordx4 v[92:95], v180, s[28:31], s3 offen sc1
    v_mul_f32 v241, 0x3fb8aa3b, v241
    v_fmamk_f32 v144, v128, 0x3fb8aa3b, v240
    v_fmamk_f32 v145, v129, 0x3fb8aa3b, v240
    v_exp_f32 v144, v144
    v_fmamk_f32 v146, v130, 0x3fb8aa3b, v240
    v_exp_f32 v145, v145
    v_fmamk_f32 v147, v131, 0x3fb8aa3b, v240
    v_exp_f32 v146, v146
    v_add_f32 v242, v144, v145
    v_fmamk_f32 v148, v132, 0x3fb8aa3b, v240
    v_exp_f32 v147, v147
    s_add_u32 s3, s67, 2
    s_and_b32 s3, s3, 7
    s_mul_i32 s3, s3, 10240
    s_add_u32 s3, s3, s88
    buffer_load_dwordx4 v[96:99], v180, s[28:31], s3 offen sc1
    v_add_f32 v242, v242, v146
    v_fmamk_f32 v149, v133, 0x3fb8aa3b, v240
    v_exp_f32 v148, v148
    v_add_f32 v242, v242, v147
    v_fmamk_f32 v150, v134, 0x3fb8aa3b, v240
    v_exp_f32 v149, v149
    v_add_f32 v242, v242, v148
    v_fmamk_f32 v151, v135, 0x3fb8aa3b, v240
    v_exp_f32 v150, v150
    v_add_f32 v242, v242, v149
    v_fmamk_f32 v152, v136, 0x3fb8aa3b, v240
    s_add_u32 s3, s67, 3
    s_and_b32 s3, s3, 7
    s_mul_i32 s3, s3, 10240
    s_add_u32 s3, s3, s88
    buffer_load_dwordx4 v[100:103], v180, s[28:31], s3 offen sc1
    v_exp_f32 v151, v151
    v_add_f32 v242, v242, v150
    v_fmamk_f32 v153, v137, 0x3fb8aa3b, v240
    v_exp_f32 v152, v152
    v_add_f32 v242, v242, v151
    v_fmamk_f32 v154, v138, 0x3fb8aa3b, v240
    v_exp_f32 v153, v153
    v_add_f32 v242, v242, v152
    v_fmamk_f32 v155, v139, 0x3fb8aa3b, v240
    v_exp_f32 v154, v154
    v_add_f32 v242, v242, v153
    s_add_u32 s3, s67, 4
    s_and_b32 s3, s3, 7
    s_mul_i32 s3, s3, 10240
    s_add_u32 s3, s3, s88
    buffer_load_dwordx4 v[104:107], v180, s[28:31], s3 offen sc1
    v_fmamk_f32 v156, v140, 0x3fb8aa3b, v240
    v_exp_f32 v155, v155
    v_add_f32 v242, v242, v154
    v_fmamk_f32 v157, v141, 0x3fb8aa3b, v240
    v_exp_f32 v156, v156
    v_add_f32 v242, v242, v155
    v_fmamk_f32 v158, v142, 0x3fb8aa3b, v240
    v_exp_f32 v157, v157
    v_add_f32 v242, v242, v156
    v_fmamk_f32 v159, v143, 0x3fb8aa3b, v240
    v_exp_f32 v158, v158
    s_add_u32 s3, s67, 5
    s_and_b32 s3, s3, 7
    s_mul_i32 s3, s3, 10240
    s_add_u32 s3, s3, s88
    buffer_load_dwordx4 v[108:111], v180, s[28:31], s3 offen sc1
    v_add_f32 v242, v242, v157
    v_exp_f32 v159, v159
    v_add_f32 v242, v242, v158
    v_add_f32 v242, v242, v159
    v_rcp_f32 v242, v242
    s_nop 0
    v_mul_f32 v144, v144, v242
    v_mul_f32 v145, v145, v242
    v_cvt_pk_bf16_f32 v216, v144, v145
    v_mul_f32 v146, v146, v242
    v_mul_f32 v147, v147, v242
    v_cvt_pk_bf16_f32 v217, v146, v147
    s_add_u32 s3, s67, 6
    s_and_b32 s3, s3, 7
    s_mul_i32 s3, s3, 10240
    s_add_u32 s3, s3, s88
    buffer_load_dwordx4 v[112:115], v180, s[28:31], s3 offen sc1
    v_mul_f32 v148, v148, v242
    v_mul_f32 v149, v149, v242
    v_cvt_pk_bf16_f32 v218, v148, v149
    v_mul_f32 v150, v150, v242
    v_mul_f32 v151, v151, v242
    v_cvt_pk_bf16_f32 v219, v150, v151
    v_mul_f32 v152, v152, v242
    s_add_u32 m0, s77, 81920
    s_xor_b32 s95, s79, 163840
    buffer_load_dwordx4 v238, s[20:23], s95 offen offset:0 lds
    v_mul_f32 v153, v153, v242
    v_cvt_pk_bf16_f32 v220, v152, v153
    v_mul_f32 v154, v154, v242
    s_add_u32 s3, s67, 7
    s_and_b32 s3, s3, 7
    s_mul_i32 s3, s3, 10240
    s_add_u32 s3, s3, s88
    buffer_load_dwordx4 v[116:119], v180, s[28:31], s3 offen sc1
    v_mul_f32 v155, v155, v242
    v_cvt_pk_bf16_f32 v221, v154, v155
    v_mul_f32 v156, v156, v242
    v_mul_f32 v157, v157, v242
    v_cvt_pk_bf16_f32 v222, v156, v157
    v_mul_f32 v158, v158, v242
    v_mul_f32 v159, v159, v242
    v_cvt_pk_bf16_f32 v223, v158, v159
    v_fmamk_f32 v128, v128, 0xbfb8aa3b, v241
    v_fmamk_f32 v129, v129, 0xbfb8aa3b, v241
    v_exp_f32 v128, v128
    v_fmamk_f32 v130, v130, 0xbfb8aa3b, v241
    v_exp_f32 v129, v129
    v_fmamk_f32 v131, v131, 0xbfb8aa3b, v241
    s_add_u32 m0, s77, 90112
    s_xor_b32 s95, s79, 180224
    buffer_load_dwordx4 v238, s[20:23], s95 offen offset:0 lds
    v_exp_f32 v130, v130
    v_add_f32 v244, v128, v129
    v_fmamk_f32 v132, v132, 0xbfb8aa3b, v241
    v_exp_f32 v131, v131
    v_add_f32 v244, v244, v130
    v_fmamk_f32 v133, v133, 0xbfb8aa3b, v241
    v_exp_f32 v132, v132
    v_add_f32 v244, v244, v131
    v_fmamk_f32 v134, v134, 0xbfb8aa3b, v241
    v_exp_f32 v133, v133
    v_add_f32 v244, v244, v132
    v_fmamk_f32 v135, v135, 0xbfb8aa3b, v241
    v_exp_f32 v134, v134
    v_add_f32 v244, v244, v133
    v_fmamk_f32 v136, v136, 0xbfb8aa3b, v241
    v_exp_f32 v135, v135
    v_add_f32 v244, v244, v134
    v_fmamk_f32 v137, v137, 0xbfb8aa3b, v241
    v_exp_f32 v136, v136
    v_add_f32 v244, v244, v135
    v_fmamk_f32 v138, v138, 0xbfb8aa3b, v241
    s_add_u32 m0, s77, 98304
    s_xor_b32 s95, s78, 0
    buffer_load_dwordx4 v247, s[20:23], s95 offen offset:0 lds
    v_exp_f32 v137, v137
    v_add_f32 v244, v244, v136
    v_fmamk_f32 v139, v139, 0xbfb8aa3b, v241
    v_exp_f32 v138, v138
    v_add_f32 v244, v244, v137
    v_fmamk_f32 v140, v140, 0xbfb8aa3b, v241
    v_exp_f32 v139, v139
    v_add_f32 v244, v244, v138
    v_fmamk_f32 v141, v141, 0xbfb8aa3b, v241
    v_exp_f32 v140, v140
    v_add_f32 v244, v244, v139
    v_fmamk_f32 v142, v142, 0xbfb8aa3b, v241
    v_exp_f32 v141, v141
    v_add_f32 v244, v244, v140
    v_fmamk_f32 v143, v143, 0xbfb8aa3b, v241
    v_exp_f32 v142, v142
    v_add_f32 v244, v244, v141
    v_exp_f32 v143, v143
    s_waitcnt vmcnt(10)
    v_mfma_f32_32x32x16_bf16 v[160:175], v[184:187], v[88:91], 0
    v_add_f32 v244, v244, v142
    v_add_f32 v244, v244, v143
    v_rcp_f32 v244, v244
    s_add_u32 m0, s77, 106496
    s_xor_b32 s95, s78, 16384
    buffer_load_dwordx4 v247, s[20:23], s95 offen offset:0 lds
    v_mul_f32 v128, v128, v244
    v_mul_f32 v129, v129, v244
    v_cvt_pk_bf16_f32 v208, v128, v129
    v_mul_f32 v130, v130, v244
    v_mul_f32 v131, v131, v244
    v_cvt_pk_bf16_f32 v209, v130, v131
    s_waitcnt vmcnt(10)
    v_mfma_f32_32x32x16_bf16 v[160:175], v[184:187], v[92:95], v[160:175]
    v_mul_f32 v132, v132, v244
    v_mul_f32 v133, v133, v244
    v_cvt_pk_bf16_f32 v210, v132, v133
    v_mul_f32 v134, v134, v244
    v_mul_f32 v135, v135, v244
    v_cvt_pk_bf16_f32 v211, v134, v135
    v_mul_f32 v136, v136, v244
    v_mul_f32 v137, v137, v244
    v_cvt_pk_bf16_f32 v212, v136, v137
    s_waitcnt vmcnt(9)
    v_mfma_f32_32x32x16_bf16 v[160:175], v[184:187], v[96:99], v[160:175]
    v_mul_f32 v138, v138, v244
    v_mul_f32 v139, v139, v244
    v_cvt_pk_bf16_f32 v213, v138, v139
    v_mul_f32 v140, v140, v244
    s_add_u32 m0, s77, 114688
    s_xor_b32 s95, s78, 32768
    buffer_load_dwordx4 v247, s[20:23], s95 offen offset:0 lds
    v_mul_f32 v141, v141, v244
    v_cvt_pk_bf16_f32 v214, v140, v141
    v_mul_f32 v142, v142, v244
    v_mul_f32 v143, v143, v244
    s_waitcnt vmcnt(9)
    v_mfma_f32_32x32x16_bf16 v[160:175], v[184:187], v[100:103], v[160:175]
    v_cvt_pk_bf16_f32 v215, v142, v143
    v_lshlrev_b32 v192, 16, v120
    v_and_b32 v193, 0xffff0000, v120
    v_lshlrev_b32 v194, 16, v121
    v_and_b32 v195, 0xffff0000, v121
    v_lshlrev_b32 v196, 16, v122
    v_and_b32 v197, 0xffff0000, v122
    v_lshlrev_b32 v198, 16, v123
    v_and_b32 v199, 0xffff0000, v123
    s_waitcnt vmcnt(8)
    v_mfma_f32_32x32x16_bf16 v[160:175], v[184:187], v[104:107], v[160:175]
    v_add_f32 v192, v192, v192 row_shr:2 bound_ctrl:0
    v_add_f32 v193, v193, v193 row_shr:2 bound_ctrl:0
    v_add_f32 v194, v194, v194 row_shr:2 bound_ctrl:0
    v_add_f32 v195, v195, v195 row_shr:2 bound_ctrl:0
    v_add_f32 v196, v196, v196 row_shr:2 bound_ctrl:0
    v_add_f32 v197, v197, v197 row_shr:2 bound_ctrl:0
    v_add_f32 v198, v198, v198 row_shr:2 bound_ctrl:0
    s_add_u32 m0, s77, 122880
    s_xor_b32 s95, s78, 49152
    buffer_load_dwordx4 v247, s[20:23], s95 offen offset:0 lds
    v_add_f32 v199, v199, v199 row_shr:2 bound_ctrl:0
    v_add_f32 v192, v192, v192 row_shr:4 bound_ctrl:0
    s_waitcnt vmcnt(8)
    v_mfma_f32_32x32x16_bf16 v[160:175], v[184:187], v[108:111], v[160:175]
    v_add_f32 v193, v193, v193 row_shr:4 bound_ctrl:0
    v_add_f32 v194, v194, v194 row_shr:4 bound_ctrl:0
    v_add_f32 v195, v195, v195 row_shr:4 bound_ctrl:0
    v_add_f32 v196, v196, v196 row_shr:4 bound_ctrl:0
    v_add_f32 v197, v197, v197 row_shr:4 bound_ctrl:0
    v_add_f32 v198, v198, v198 row_shr:4 bound_ctrl:0
    v_add_f32 v199, v199, v199 row_shr:4 bound_ctrl:0
    v_add_f32 v192, v192, v192 row_shr:8 bound_ctrl:0
    v_add_f32 v193, v193, v193 row_shr:8 bound_ctrl:0
    s_waitcnt vmcnt(7)
    v_mfma_f32_32x32x16_bf16 v[160:175], v[184:187], v[112:115], v[160:175]
    v_add_f32 v194, v194, v194 row_shr:8 bound_ctrl:0
    v_add_f32 v195, v195, v195 row_shr:8 bound_ctrl:0
    v_add_f32 v196, v196, v196 row_shr:8 bound_ctrl:0
    v_add_f32 v197, v197, v197 row_shr:8 bound_ctrl:0
    v_add_f32 v198, v198, v198 row_shr:8 bound_ctrl:0
    v_add_f32 v199, v199, v199 row_shr:8 bound_ctrl:0
    v_mov_b32 v200, v192
    v_mov_b32 v201, v193
    s_add_u32 m0, s77, 131072
    s_xor_b32 s95, s78, 65536
    buffer_load_dwordx4 v247, s[20:23], s95 offen offset:0 lds
    v_mov_b32 v202, v194
    s_waitcnt vmcnt(6)
    v_mfma_f32_32x32x16_bf16 v[160:175], v[184:187], v[116:119], v[160:175]
    v_mov_b32 v203, v195
    v_mov_b32 v204, v196
    v_mov_b32 v205, v197
    v_mov_b32 v206, v198
    v_mov_b32 v207, v199
    v_permlane16_swap_b32 v192, v200
    v_permlane16_swap_b32 v193, v201
    v_permlane16_swap_b32 v194, v202
    v_permlane16_swap_b32 v195, v203
    v_permlane16_swap_b32 v196, v204
    v_permlane16_swap_b32 v197, v205
    v_permlane16_swap_b32 v198, v206
    v_permlane16_swap_b32 v199, v207
    v_add_f32 v192, v192, v200
    v_add_f32 v193, v193, v201
    v_add_f32 v194, v194, v202
    v_add_f32 v195, v195, v203
    v_add_f32 v196, v196, v204
    v_add_f32 v197, v197, v205
    v_add_f32 v198, v198, v206
    s_cmp_lg_u32 s64, 0
    s_cbranch_scc1 L_pi_26
    s_add_u32 s97, s86, 0
    buffer_load_dword v251, v250, s[28:31], s97 offen sc1
L_pi_26:
    v_add_f32 v199, v199, v207
    v_cvt_pk_bf16_f32 v200, v192, v193
    v_cvt_pk_bf16_f32 v201, v194, v195
    v_cvt_pk_bf16_f32 v202, v196, v197
    v_cvt_pk_bf16_f32 v203, v198, v199
    s_mov_b64 exec, 0xc000
    ds_write_b128 v179, v[200:203]
    s_mov_b64 exec, -1
    v_cvt_pk_bf16_f32 v204, v160, v161
    v_cvt_pk_bf16_f32 v205, v162, v163
    ds_write_b64 v178, v[204:205]
    s_waitcnt lgkmcnt(0)
    s_barrier
    ds_read_b128 v[192:195], v176 offset:0
    ds_read_b128 v[196:199], v176 offset:16
    ds_read_b128 v[200:203], v176 offset:32
    ds_read_b128 v[204:207], v176 offset:48
    ds_read_b128 v[128:131], v177 offset:0
    ds_read_b128 v[132:135], v177 offset:16
    ds_read_b128 v[136:139], v177 offset:32
    ds_read_b128 v[140:143], v177 offset:48
    s_add_u32 m0, s77, 139264
    s_xor_b32 s95, s78, 81920
    buffer_load_dwordx4 v247, s[20:23], s95 offen offset:0 lds
    s_waitcnt lgkmcnt(7)
    v_mfma_f32_32x32x16_bf16 v[144:159], v[192:195], v[216:219], 0
    s_waitcnt lgkmcnt(6)
    v_mfma_f32_32x32x16_bf16 v[144:159], v[196:199], v[220:223], v[144:159]
    s_waitcnt lgkmcnt(5)
    v_mfma_f32_32x32x16_bf16 v[144:159], v[200:203], v[208:211], v[144:159]
    s_waitcnt lgkmcnt(4)
    v_mfma_f32_32x32x16_bf16 v[144:159], v[204:207], v[212:215], v[144:159]
    s_waitcnt lgkmcnt(3)
    v_mfma_f32_32x32x16_bf16 v[160:175], v[128:131], v[216:219], 0
    s_waitcnt lgkmcnt(2)
    v_mfma_f32_32x32x16_bf16 v[160:175], v[132:135], v[220:223], v[160:175]
    s_waitcnt lgkmcnt(1)
    v_mfma_f32_32x32x16_bf16 v[160:175], v[136:139], v[208:211], v[160:175]
    s_waitcnt lgkmcnt(0)
    v_mfma_f32_32x32x16_bf16 v[160:175], v[140:143], v[212:215], v[160:175]
    s_nop 3
    v_add_f32 v240, 0x358637bd, v144
    v_add_f32 v241, 0x358637bd, v152
    v_rcp_f32 v240, v240
    v_rcp_f32 v241, v241
    s_nop 3
    v_mul_f32 v160, v160, v240
    v_mul_f32 v161, v161, v240
    v_mul_f32 v162, v162, v240
    v_mul_f32 v163, v163, v240
    s_add_u32 m0, s77, 40960
    s_xor_b32 s95, s78, 32768
    buffer_load_dwordx4 v252, s[24:27], s95 offen offset:0 lds
    v_mul_f32 v164, v164, v240
    v_mul_f32 v165, v165, v240
    v_mul_f32 v166, v166, v240
    v_mul_f32 v167, v167, v240
    v_cvt_pk_bf16_f32 v176, v160, v161
    v_cvt_pk_bf16_f32 v177, v162, v163
    v_cvt_pk_bf16_f32 v178, v164, v165
    v_cvt_pk_bf16_f32 v179, v166, v167
    buffer_store_dwordx4 v[176:179], v239, s[28:31], s90 offen offset:0 sc1
    v_mul_f32 v168, v168, v241
    v_mul_f32 v169, v169, v241
    v_mul_f32 v170, v170, v241
    v_mul_f32 v171, v171, v241
    v_mul_f32 v172, v172, v241
    v_mul_f32 v173, v173, v241
    v_mul_f32 v174, v174, v241
    v_mul_f32 v175, v175, v241
    v_cvt_pk_bf16_f32 v180, v168, v169
    v_cvt_pk_bf16_f32 v181, v170, v171
    v_cvt_pk_bf16_f32 v182, v172, v173
    v_cvt_pk_bf16_f32 v183, v174, v175
    buffer_store_dwordx4 v[180:183], v239, s[28:31], s90 offen offset:1024 sc1
L_phase2:
    s_waitcnt vmcnt(8)
    s_cmp_lg_u32 s64, 0
    s_cbranch_scc1 L_pc_27
    s_waitcnt vmcnt(4)
    v_cmp_ne_u32 vcc, s72, v251
    s_mov_b32 s96, 0
    s_cbranch_vccz L_pc_27
L_pl_28:
    s_waitcnt vmcnt(4)
    buffer_load_dword v251, v250, s[28:31], s97 offen sc1
    s_waitcnt vmcnt(0)
    s_waitcnt vmcnt(4)
    v_cmp_ne_u32 vcc, s72, v251
    s_add_u32 s96, s96, 1
    s_cmp_gt_u32 s96, 200000
    s_cbranch_scc1 L_pc_27
    s_cbranch_vccz L_pc_27
    s_sleep 1
    s_branch L_pl_28
L_pc_27:
    s_barrier
    s_xor_b32 s3, s81, 0
    buffer_load_dwordx4 v[88:91], v253, s[28:31], s3 offen sc1
    s_xor_b32 s3, s81, 1024
    buffer_load_dwordx4 v[92:95], v253, s[28:31], s3 offen sc1
    s_xor_b32 s3, s81, 2048
    buffer_load_dwordx4 v[96:99], v253, s[28:31], s3 offen sc1
    s_xor_b32 s3, s81, 3072
    buffer_load_dwordx4 v[100:103], v253, s[28:31], s3 offen sc1
    s_xor_b32 s3, s81, 4096
    buffer_load_dwordx4 v[104:107], v253, s[28:31], s3 offen sc1
    ds_read_b64_tr_b16 v[80:81], v236 offset:16384
    ds_read_b64_tr_b16 v[82:83], v236 offset:17408
    ds_read_b64_tr_b16 v[84:85], v237 offset:16384
    ds_read_b64_tr_b16 v[86:87], v237 offset:17408
    v_and_b32 v240, 31, v255
    v_lshrrev_b32 v233, 3, v240
    v_lshlrev_b32 v233, 7, v233
    v_and_b32 v241, 28, v249
    v_add_u32 v233, v233, v241
    s_lshl_b32 s89, s70, 1
    s_add_u32 s89, s89, s66
    s_lshl_b32 s89, s89, 9
    s_add_u32 s89, s89, 1048576
    v_lshrrev_b32 v241, 5, v255
    v_and_b32 v243, 7, v255
    v_xor_b32 v241, v241, v243
    v_lshlrev_b32 v241, 4, v241
    s_lshl_b32 s6, s65, 14
    s_lshl_b32 s7, s66, 13
    s_add_u32 s6, s6, s7
    s_add_u32 s6, s6, 90112
    v_lshl_add_u32 v240, v240, 8, s6
    v_add_u32 v226, v240, v241
    v_xor_b32 v227, 32, v226
    v_xor_b32 v228, 64, v226
    v_xor_b32 v229, 96, v226
    v_lshrrev_b32 v240, 3, v255
    v_lshlrev_b32 v241, 1, v243
    v_xor_b32 v241, v241, v240
    v_lshlrev_b32 v241, 4, v241
    s_lshl_b32 s6, s64, 3
    v_add_u32 v240, s6, v240
    v_lshl_add_u32 v241, v240, 8, v241
    v_add_u32 v230, 90112, v241
    v_xor_b32 v231, 16, v230
    v_lshlrev_b32 v243, 4, v243
    v_lshl_add_u32 v232, v240, 10, v243
    s_lshl_b32 s88, s70, 16
    s_lshl_b32 s7, s71, 7
    s_add_u32 s88, s88, s7
    s_xor_b32 s92, s64, 7
    s_or_b32 s92, s92, s2
    s_mov_b32 s87, 753664
    s_add_u32 s84, s87, 16384
    v_lshlrev_b32 v234, 8, v255
    s_waitcnt vmcnt(5) lgkmcnt(0)
    s_barrier
    buffer_store_dword v248, v249, s[28:31], s85 offen sc1
    s_add_u32 m0, s77, 49152
    s_xor_b32 s95, s78, 49152
    buffer_load_dwordx4 v252, s[24:27], s95 offen offset:0 lds
    s_add_u32 m0, s77, 57344
    s_xor_b32 s95, s78, 65536
    buffer_load_dwordx4 v252, s[24:27], s95 offen offset:0 lds
    s_waitcnt vmcnt(7)
    v_mfma_f32_32x32x16_bf16 v[128:143], v[0:3], v[88:91], 0
    s_add_u32 m0, s77, 65536
    s_xor_b32 s95, s78, 81920
    buffer_load_dwordx4 v252, s[24:27], s95 offen offset:0 lds
    s_xor_b32 s3, s81, 5120
    buffer_load_dwordx4 v[108:111], v253, s[28:31], s3 offen sc1
    s_xor_b32 s3, s81, 6144
    buffer_load_dwordx4 v[112:115], v253, s[28:31], s3 offen sc1
    v_mfma_f32_32x32x16_bf16 v[144:159], v[4:7], v[88:91], 0
    s_add_u32 m0, s77, 73728
    s_xor_b32 s95, s78, 98304
    buffer_load_dwordx4 v252, s[24:27], s95 offen offset:0 lds
    s_xor_b32 s3, s81, 7168
    buffer_load_dwordx4 v[116:119], v253, s[28:31], s3 offen sc1
    s_xor_b32 s3, s82, 8192
    buffer_load_dwordx4 v[120:123], v253, s[28:31], s3 offen sc1
    s_waitcnt vmcnt(12)
    v_mfma_f32_32x32x16_bf16 v[128:143], v[8:11], v[92:95], v[128:143]
    s_add_u32 m0, s77, 81920
    s_xor_b32 s95, s78, 114688
    buffer_load_dwordx4 v252, s[24:27], s95 offen offset:0 lds
    s_xor_b32 s3, s82, 9216
    buffer_load_dwordx4 v[124:127], v253, s[28:31], s3 offen sc1
    s_xor_b32 s3, s82, 10240
    buffer_load_dwordx4 v[88:91], v253, s[28:31], s3 offen sc1
    v_mfma_f32_32x32x16_bf16 v[144:159], v[12:15], v[92:95], v[144:159]
    s_xor_b32 s3, s82, 11264
    buffer_load_dwordx4 v[92:95], v253, s[28:31], s3 offen sc1
    s_cmp_lg_u32 s64, 0
    s_cbranch_scc1 L_pi_29
    s_add_u32 s97, s86, 32768
    buffer_load_dword v251, v250, s[28:31], s97 offen sc1
L_pi_29:
    s_waitcnt vmcnt(15)
    v_mfma_f32_32x32x16_bf16 v[128:143], v[16:19], v[96:99], v[128:143]
    v_mfma_f32_32x32x16_bf16 v[144:159], v[20:23], v[96:99], v[144:159]
    s_waitcnt vmcnt(14)
    v_mfma_f32_32x32x16_bf16 v[128:143], v[24:27], v[100:103], v[128:143]
    v_mfma_f32_32x32x16_bf16 v[144:159], v[28:31], v[100:103], v[144:159]
    s_waitcnt vmcnt(13)
    v_mfma_f32_32x32x16_bf16 v[128:143], v[32:35], v[104:107], v[128:143]
    v_mfma_f32_32x32x16_bf16 v[144:159], v[36:39], v[104:107], v[144:159]
    s_waitcnt vmcnt(8)
    v_mfma_f32_32x32x16_bf16 v[128:143], v[40:43], v[108:111], v[128:143]
    v_mfma_f32_32x32x16_bf16 v[144:159], v[44:47], v[108:111], v[144:159]
    s_cmp_lg_u32 s64, 0
    s_cbranch_scc1 L_pc_30
    s_waitcnt vmcnt(0)
    v_cmp_ne_u32 vcc, s72, v251
    s_mov_b32 s96, 0
    s_cbranch_vccz L_pc_30
L_pl_31:
    s_waitcnt vmcnt(0)
    buffer_load_dword v251, v250, s[28:31], s97 offen sc1
    s_waitcnt vmcnt(0)
    s_waitcnt vmcnt(0)
    v_cmp_ne_u32 vcc, s72, v251
    s_add_u32 s96, s96, 1
    s_cmp_gt_u32 s96, 200000
    s_cbranch_scc1 L_pc_30
    s_cbranch_vccz L_pc_30
    s_sleep 1
    s_branch L_pl_31
L_pc_30:
    s_barrier
    buffer_load_dword v225, v233, s[28:31], s89 offen sc1
    v_add_u32 v253, s40, v253
    s_xor_b32 s3, s81, 0
    buffer_load_dwordx4 v[96:99], v253, s[28:31], s3 offen sc1
    s_xor_b32 s3, s81, 1024
    buffer_load_dwordx4 v[100:103], v253, s[28:31], s3 offen sc1
    s_waitcnt vmcnt(10)
    v_mfma_f32_32x32x16_bf16 v[128:143], v[48:51], v[112:115], v[128:143]
    s_xor_b32 s3, s81, 2048
    buffer_load_dwordx4 v[104:107], v253, s[28:31], s3 offen sc1
    s_xor_b32 s3, s81, 3072
    buffer_load_dwordx4 v[108:111], v253, s[28:31], s3 offen sc1
    v_mfma_f32_32x32x16_bf16 v[144:159], v[52:55], v[112:115], v[144:159]
    s_xor_b32 s3, s81, 4096
    buffer_load_dwordx4 v[112:115], v253, s[28:31], s3 offen sc1
    s_waitcnt vmcnt(11)
    v_mfma_f32_32x32x16_bf16 v[128:143], v[56:59], v[116:119], v[128:143]
    v_mfma_f32_32x32x16_bf16 v[144:159], v[60:63], v[116:119], v[144:159]
    s_xor_b32 s3, s81, 5120
    buffer_load_dwordx4 v[116:119], v253, s[28:31], s3 offen sc1
    s_waitcnt vmcnt(11)
    v_mfma_f32_32x32x16_bf16 v[128:143], v[64:67], v[120:123], v[128:143]
    v_mfma_f32_32x32x16_bf16 v[144:159], v[68:71], v[120:123], v[144:159]
    s_xor_b32 s3, s81, 6144
    buffer_load_dwordx4 v[120:123], v253, s[28:31], s3 offen sc1
    s_waitcnt vmcnt(10)
    v_mfma_f32_32x32x16_bf16 v[128:143], v[72:75], v[124:127], v[128:143]
    ds_read_b64_tr_b16 v[208:209], v236 offset:24576
    ds_read_b64_tr_b16 v[210:211], v236 offset:25600
    v_mfma_f32_32x32x16_bf16 v[144:159], v[76:79], v[124:127], v[144:159]
    ds_read_b64_tr_b16 v[212:213], v237 offset:24576
    ds_read_b64_tr_b16 v[214:215], v237 offset:25600
    s_xor_b32 s3, s81, 7168
    buffer_load_dwordx4 v[124:127], v253, s[28:31], s3 offen sc1
    s_cmp_lg_u32 s64, 0
    s_cbranch_scc1 L_pi_32
    s_add_u32 s97, s86, 65536
    s_waitcnt vmcnt(9)
    buffer_load_dword v251, v250, s[28:31], s97 offen sc1
L_pi_32:
    s_waitcnt vmcnt(10)
    v_mfma_f32_32x32x16_bf16 v[128:143], v[80:83], v[88:91], v[128:143]
    ds_read_b64_tr_b16 v[192:193], v236 offset:32768
    ds_read_b64_tr_b16 v[194:195], v236 offset:33792
    v_mfma_f32_32x32x16_bf16 v[144:159], v[84:87], v[88:91], v[144:159]
    ds_read_b64_tr_b16 v[196:197], v237 offset:32768
    ds_read_b64_tr_b16 v[198:199], v237 offset:33792
    s_xor_b32 s3, s83, 8192
    buffer_load_dwordx4 v[88:91], v253, s[28:31], s3 offen sc1
    s_waitcnt vmcnt(10) lgkmcnt(6)
    v_mfma_f32_32x32x16_bf16 v[128:143], v[208:211], v[92:95], v[128:143]
    ds_read_b64_tr_b16 v[200:201], v236 offset:40960
    ds_read_b64_tr_b16 v[202:203], v236 offset:41984
    s_waitcnt lgkmcnt(6)
    v_mfma_f32_32x32x16_bf16 v[144:159], v[212:215], v[92:95], v[144:159]
    ds_read_b64_tr_b16 v[204:205], v237 offset:40960
    ds_read_b64_tr_b16 v[206:207], v237 offset:41984
    s_xor_b32 s3, s83, 9216
    buffer_load_dwordx4 v[92:95], v253, s[28:31], s3 offen sc1
    s_waitcnt vmcnt(9) lgkmcnt(6)
    v_mfma_f32_32x32x16_bf16 v[128:143], v[192:195], v[96:99], v[128:143]
    ds_read_b64_tr_b16 v[208:209], v236 offset:49152
    ds_read_b64_tr_b16 v[210:211], v236 offset:50176
    s_waitcnt lgkmcnt(6)
    v_mfma_f32_32x32x16_bf16 v[144:159], v[196:199], v[96:99], v[144:159]
    ds_read_b64_tr_b16 v[212:213], v237 offset:49152
    ds_read_b64_tr_b16 v[214:215], v237 offset:50176
    s_waitcnt vmcnt(8) lgkmcnt(6)
    v_mfma_f32_32x32x16_bf16 v[128:143], v[200:203], v[100:103], v[128:143]
    ds_read_b64_tr_b16 v[192:193], v236 offset:57344
    ds_read_b64_tr_b16 v[194:195], v236 offset:58368
    s_waitcnt lgkmcnt(6)
    v_mfma_f32_32x32x16_bf16 v[144:159], v[204:207], v[100:103], v[144:159]
    ds_read_b64_tr_b16 v[196:197], v237 offset:57344
    ds_read_b64_tr_b16 v[198:199], v237 offset:58368
    s_cmp_lg_u32 s64, 0
    s_cbranch_scc1 L_pc_33
    s_waitcnt vmcnt(2)
    v_cmp_ne_u32 vcc, s72, v251
    s_mov_b32 s96, 0
    s_cbranch_vccz L_pc_33
L_pl_34:
    s_waitcnt vmcnt(2)
    buffer_load_dword v251, v250, s[28:31], s97 offen sc1
    s_waitcnt vmcnt(0)
    s_waitcnt vmcnt(2)
    v_cmp_ne_u32 vcc, s72, v251
    s_add_u32 s96, s96, 1
    s_cmp_gt_u32 s96, 200000
    s_cbranch_scc1 L_pc_33
    s_cbranch_vccz L_pc_33
    s_sleep 1
    s_branch L_pl_34
L_pc_33:
    s_barrier
    v_add_u32 v253, s48, v253
    s_xor_b32 s3, s81, 0
    buffer_load_dwordx4 v[96:99], v253, s[28:31], s3 offen sc1
    s_xor_b32 s3, s81, 1024
    buffer_load_dwordx4 v[100:103], v253, s[28:31], s3 offen sc1
    s_waitcnt vmcnt(9) lgkmcnt(6)
    v_mfma_f32_32x32x16_bf16 v[128:143], v[208:211], v[104:107], v[128:143]
    v_add_u32 v236, 65536, v236
    v_add_u32 v237, 65536, v237
    ds_read_b64_tr_b16 v[200:201], v236 offset:0
    ds_read_b64_tr_b16 v[202:203], v236 offset:1024
    s_waitcnt lgkmcnt(6)
    v_mfma_f32_32x32x16_bf16 v[144:159], v[212:215], v[104:107], v[144:159]
    ds_read_b64_tr_b16 v[204:205], v237 offset:0
    ds_read_b64_tr_b16 v[206:207], v237 offset:1024
    s_xor_b32 s3, s81, 2048
    buffer_load_dwordx4 v[104:107], v253, s[28:31], s3 offen sc1
    s_waitcnt vmcnt(9) lgkmcnt(6)
    v_mfma_f32_32x32x16_bf16 v[128:143], v[192:195], v[108:111], v[128:143]
    ds_read_b64_tr_b16 v[208:209], v236 offset:8192
    ds_read_b64_tr_b16 v[210:211], v236 offset:9216
    s_waitcnt lgkmcnt(6)
    v_mfma_f32_32x32x16_bf16 v[144:159], v[196:199], v[108:111], v[144:159]
    ds_read_b64_tr_b16 v[212:213], v237 offset:8192
    ds_read_b64_tr_b16 v[214:215], v237 offset:9216
    s_xor_b32 s3, s81, 3072
    buffer_load_dwordx4 v[108:111], v253, s[28:31], s3 offen sc1
    s_waitcnt vmcnt(9) lgkmcnt(6)
    v_mfma_f32_32x32x16_bf16 v[128:143], v[200:203], v[112:115], v[128:143]
    ds_read_b64_tr_b16 v[192:193], v236 offset:16896
    ds_read_b64_tr_b16 v[194:195], v236 offset:17920
    s_waitcnt lgkmcnt(6)
    v_mfma_f32_32x32x16_bf16 v[144:159], v[204:207], v[112:115], v[144:159]
    ds_read_b64_tr_b16 v[196:197], v237 offset:16896
    ds_read_b64_tr_b16 v[198:199], v237 offset:17920
    s_xor_b32 s3, s81, 4096
    buffer_load_dwordx4 v[112:115], v253, s[28:31], s3 offen sc1
    s_waitcnt vmcnt(9) lgkmcnt(6)
    v_mfma_f32_32x32x16_bf16 v[128:143], v[208:211], v[116:119], v[128:143]
    v_subrev_u32 v236, 131072, v236
    v_subrev_u32 v237, 131072, v237
    ds_read_b64_tr_b16 v[200:201], v236 offset:0
    ds_read_b64_tr_b16 v[202:203], v236 offset:1024
    s_waitcnt lgkmcnt(6)
    v_mfma_f32_32x32x16_bf16 v[144:159], v[212:215], v[116:119], v[144:159]
    ds_read_b64_tr_b16 v[204:205], v237 offset:0
    ds_read_b64_tr_b16 v[206:207], v237 offset:1024
    s_xor_b32 s3, s81, 5120
    buffer_load_dwordx4 v[116:119], v253, s[28:31], s3 offen sc1
    s_waitcnt vmcnt(9) lgkmcnt(6)
    v_mfma_f32_32x32x16_bf16 v[128:143], v[192:195], v[120:123], v[128:143]
    ds_read_b64_tr_b16 v[208:209], v236 offset:8192
    ds_read_b64_tr_b16 v[210:211], v236 offset:9216
    s_waitcnt lgkmcnt(6)
    v_mfma_f32_32x32x16_bf16 v[144:159], v[196:199], v[120:123], v[144:159]
    ds_read_b64_tr_b16 v[212:213], v237 offset:8192
    ds_read_b64_tr_b16 v[214:215], v237 offset:9216
    s_xor_b32 s3, s81, 6144
    buffer_load_dwordx4 v[120:123], v253, s[28:31], s3 offen sc1
    s_waitcnt lgkmcnt(0)
    s_barrier
    s_waitcnt vmcnt(9)
    v_mfma_f32_32x32x16_bf16 v[128:143], v[200:203], v[124:127], v[128:143]
    ds_read_b64_tr_b16 v[192:193], v236 offset:16384
    ds_read_b64_tr_b16 v[194:195], v236 offset:17408
    v_mfma_f32_32x32x16_bf16 v[144:159], v[204:207], v[124:127], v[144:159]
    ds_read_b64_tr_b16 v[196:197], v237 offset:16384
    ds_read_b64_tr_b16 v[198:199], v237 offset:17408
    s_xor_b32 s3, s81, 7168
    buffer_load_dwordx4 v[124:127], v253, s[28:31], s3 offen sc1
    s_cmp_lg_u32 s92, 0
    s_cbranch_scc1 L_nq_35
    buffer_load_dword v245, v234, s[28:31], s87 offen sc1
    buffer_load_dword v246, v234, s[28:31], s84 offen sc1
L_nq_35:
    s_waitcnt vmcnt(9)
    v_mfma_f32_32x32x16_bf16 v[128:143], v[208:211], v[88:91], v[128:143]
    ds_read_b64_tr_b16 v[200:201], v236 offset:24576
    ds_read_b64_tr_b16 v[202:203], v236 offset:25600
    v_mfma_f32_32x32x16_bf16 v[144:159], v[212:215], v[88:91], v[144:159]
    ds_read_b64_tr_b16 v[204:205], v236 offset:32768
    ds_read_b64_tr_b16 v[206:207], v236 offset:33792
    s_waitcnt vmcnt(8) lgkmcnt(6)
    v_mfma_f32_32x32x16_bf16 v[128:143], v[192:195], v[92:95], v[128:143]
    ds_read_b64_tr_b16 v[208:209], v236 offset:40960
    ds_read_b64_tr_b16 v[210:211], v236 offset:41984
    v_sub_f32 v244, 1.0, v225
    s_waitcnt lgkmcnt(6)
    v_mfma_f32_32x32x16_bf16 v[144:159], v[196:199], v[92:95], v[144:159]
    ds_read_b64_tr_b16 v[212:213], v236 offset:49152
    ds_read_b64_tr_b16 v[214:215], v236 offset:50176
    s_waitcnt vmcnt(7) lgkmcnt(6)
    v_mfma_f32_32x32x16_bf16 v[160:175], v[200:203], v[96:99], 0
    ds_read_b64_tr_b16 v[192:193], v236 offset:57344
    ds_read_b64_tr_b16 v[194:195], v236 offset:58368
    s_waitcnt vmcnt(6) lgkmcnt(6)
    v_mfma_f32_32x32x16_bf16 v[160:175], v[204:207], v[100:103], v[160:175]
    v_add_u32 v236, 65536, v236
    v_add_u32 v237, 65536, v237
    ds_read_b64_tr_b16 v[196:197], v236 offset:0
    ds_read_b64_tr_b16 v[198:199], v236 offset:1024
    s_waitcnt vmcnt(5) lgkmcnt(6)
    v_mfma_f32_32x32x16_bf16 v[160:175], v[208:211], v[104:107], v[160:175]
    ds_read_b64_tr_b16 v[200:201], v236 offset:8192
    ds_read_b64_tr_b16 v[202:203], v236 offset:9216
    v_mul_f32 v128, v128, v244
    v_mul_f32 v129, v129, v244
    v_mul_f32 v130, v130, v244
    v_mul_f32 v131, v131, v244
    v_mul_f32 v132, v132, v244
    v_mul_f32 v133, v133, v244
    s_waitcnt vmcnt(4) lgkmcnt(6)
    v_mfma_f32_32x32x16_bf16 v[160:175], v[212:215], v[108:111], v[160:175]
    ds_read_b64_tr_b16 v[204:205], v236 offset:16384
    ds_read_b64_tr_b16 v[206:207], v236 offset:17408
    v_mul_f32 v134, v134, v244
    v_mul_f32 v135, v135, v244
    v_mul_f32 v136, v136, v244
    v_mul_f32 v137, v137, v244
    v_mul_f32 v138, v138, v244
    v_mul_f32 v139, v139, v244
    s_waitcnt vmcnt(3) lgkmcnt(6)
    v_mfma_f32_32x32x16_bf16 v[160:175], v[192:195], v[112:115], v[160:175]
    v_subrev_u32 v236, 65536, v236
    v_subrev_u32 v237, 65536, v237
    ds_read_b64_tr_b16 v[208:209], v237 offset:24576
    ds_read_b64_tr_b16 v[210:211], v237 offset:25600
    v_mul_f32 v140, v140, v244
    v_mul_f32 v141, v141, v244
    v_mul_f32 v142, v142, v244
    v_mul_f32 v143, v143, v244
    v_mul_f32 v144, v144, v244
    v_mul_f32 v145, v145, v244
    s_waitcnt vmcnt(2) lgkmcnt(6)
    v_mfma_f32_32x32x16_bf16 v[160:175], v[196:199], v[116:119], v[160:175]
    ds_read_b64_tr_b16 v[212:213], v237 offset:32768
    ds_read_b64_tr_b16 v[214:215], v237 offset:33792
    v_mul_f32 v146, v146, v244
    v_mul_f32 v147, v147, v244
    v_mul_f32 v148, v148, v244
    v_mul_f32 v149, v149, v244
    v_mul_f32 v150, v150, v244
    v_mul_f32 v151, v151, v244
    s_waitcnt vmcnt(1) lgkmcnt(6)
    v_mfma_f32_32x32x16_bf16 v[160:175], v[200:203], v[120:123], v[160:175]
    ds_read_b64_tr_b16 v[192:193], v237 offset:40960
    ds_read_b64_tr_b16 v[194:195], v237 offset:41984
    v_mul_f32 v152, v152, v244
    v_mul_f32 v153, v153, v244
    v_mul_f32 v154, v154, v244
    v_mul_f32 v155, v155, v244
    v_mul_f32 v156, v156, v244
    v_mul_f32 v157, v157, v244
    s_waitcnt vmcnt(0) lgkmcnt(6)
    v_mfma_f32_32x32x16_bf16 v[160:175], v[204:207], v[124:127], v[160:175]
    ds_read_b64_tr_b16 v[196:197], v237 offset:49152
    ds_read_b64_tr_b16 v[198:199], v237 offset:50176
    v_mul_f32 v158, v158, v244
    v_mul_f32 v159, v159, v244
    s_waitcnt lgkmcnt(6)
    v_mfma_f32_32x32x16_bf16 v[176:191], v[208:211], v[96:99], 0
    ds_read_b64_tr_b16 v[200:201], v237 offset:57344
    ds_read_b64_tr_b16 v[202:203], v237 offset:58368
    s_cmp_lg_u32 s92, 0
    s_cbranch_scc1 L_nw_36
    s_mov_b32 s96, 0
L_nl_37:
    s_waitcnt vmcnt(0)
    v_cmp_ne_u32 vcc, s72, v245
    s_waitcnt vmcnt(0)
    v_cmp_ne_u32 s[4:5], s72, v246
    s_add_u32 s96, s96, 1
    s_or_b64 vcc, vcc, s[4:5]
    s_cmp_eq_u64 vcc, 0
    s_cbranch_scc1 L_nx_38
    s_cmp_gt_u32 s96, 200000
    s_cbranch_scc1 L_nw_36
    s_waitcnt vmcnt(0)
    buffer_load_dword v245, v234, s[28:31], s87 offen sc1
    s_waitcnt vmcnt(1)
    buffer_load_dword v246, v234, s[28:31], s84 offen sc1
    s_waitcnt vmcnt(0)
    s_branch L_nl_37
L_nx_38:
    s_add_u32 s6, s73, 1
    v_mov_b32 v240, s6
    s_mov_b64 exec, 1
    buffer_store_dword v240, off, s[28:31], 0 sc1
    s_mov_b64 exec, -1
L_nw_36:
    s_waitcnt lgkmcnt(6)
    v_mfma_f32_32x32x16_bf16 v[176:191], v[212:215], v[100:103], v[176:191]
    v_add_u32 v236, 65536, v236
    v_add_u32 v237, 65536, v237
    ds_read_b64_tr_b16 v[204:205], v237 offset:0
    ds_read_b64_tr_b16 v[206:207], v237 offset:1024
    s_waitcnt lgkmcnt(6)
    v_mfma_f32_32x32x16_bf16 v[176:191], v[192:195], v[104:107], v[176:191]
    ds_read_b64_tr_b16 v[208:209], v237 offset:8192
    ds_read_b64_tr_b16 v[210:211], v237 offset:9216
    v_fmac_f32 v128, v160, v225
    v_fmac_f32 v129, v161, v225
    v_fmac_f32 v130, v162, v225
    v_fmac_f32 v131, v163, v225
    s_waitcnt lgkmcnt(6)
    v_mfma_f32_32x32x16_bf16 v[176:191], v[196:199], v[108:111], v[176:191]
    ds_read_b64_tr_b16 v[212:213], v237 offset:16384
    ds_read_b64_tr_b16 v[214:215], v237 offset:17408
    ds_write_b128 v226, v[128:131] offset:0
    v_fmac_f32 v132, v164, v225
    v_fmac_f32 v133, v165, v225
    v_fmac_f32 v134, v166, v225
    s_waitcnt lgkmcnt(7)
    v_mfma_f32_32x32x16_bf16 v[176:191], v[200:203], v[112:115], v[176:191]
    v_fmac_f32 v135, v167, v225
    ds_write_b128 v227, v[132:135] offset:0
    v_fmac_f32 v136, v168, v225
    v_fmac_f32 v137, v169, v225
    s_waitcnt lgkmcnt(6)
    v_mfma_f32_32x32x16_bf16 v[176:191], v[204:207], v[116:119], v[176:191]
    v_fmac_f32 v138, v170, v225
    v_fmac_f32 v139, v171, v225
    ds_write_b128 v228, v[136:139] offset:0
    v_fmac_f32 v140, v172, v225
    s_waitcnt lgkmcnt(5)
    v_mfma_f32_32x32x16_bf16 v[176:191], v[208:211], v[120:123], v[176:191]
    v_fmac_f32 v141, v173, v225
    v_fmac_f32 v142, v174, v225
    v_fmac_f32 v143, v175, v225
    ds_write_b128 v229, v[140:143] offset:0
    s_waitcnt lgkmcnt(4)
    v_mfma_f32_32x32x16_bf16 v[176:191], v[212:215], v[124:127], v[176:191]
    s_nop 11
    v_fmac_f32 v144, v176, v225
    v_fmac_f32 v145, v177, v225
    v_fmac_f32 v146, v178, v225
    v_fmac_f32 v147, v179, v225
    ds_write_b128 v226, v[144:147] offset:128
    v_fmac_f32 v148, v180, v225
    v_fmac_f32 v149, v181, v225
    v_fmac_f32 v150, v182, v225
    v_fmac_f32 v151, v183, v225
    ds_write_b128 v227, v[148:151] offset:128
    v_fmac_f32 v152, v184, v225
    v_fmac_f32 v153, v185, v225
    v_fmac_f32 v154, v186, v225
    v_fmac_f32 v155, v187, v225
    ds_write_b128 v228, v[152:155] offset:128
    v_fmac_f32 v156, v188, v225
    v_fmac_f32 v157, v189, v225
    v_fmac_f32 v158, v190, v225
    v_fmac_f32 v159, v191, v225
    ds_write_b128 v229, v[156:159] offset:128
    s_waitcnt lgkmcnt(0)
    s_barrier
    ds_read_b128 v[0:3], v230 offset:0
    ds_read_b128 v[4:7], v231 offset:0
    ds_read_b128 v[8:11], v230 offset:16384
    ds_read_b128 v[12:15], v231 offset:16384
    ds_read_b128 v[16:19], v230 offset:32768
    ds_read_b128 v[20:23], v231 offset:32768
    ds_read_b128 v[24:27], v230 offset:49152
    ds_read_b128 v[28:31], v231 offset:49152
    s_waitcnt lgkmcnt(5)
    v_add_f32 v0, v0, v8
    v_add_f32 v1, v1, v9
    v_add_f32 v2, v2, v10
    v_add_f32 v3, v3, v11
    s_waitcnt lgkmcnt(4)
    v_add_f32 v4, v4, v12
    v_add_f32 v5, v5, v13
    v_add_f32 v6, v6, v14
    v_add_f32 v7, v7, v15
    s_waitcnt lgkmcnt(1)
    v_add_f32 v16, v16, v24
    v_add_f32 v17, v17, v25
    v_add_f32 v18, v18, v26
    v_add_f32 v19, v19, v27
    s_waitcnt lgkmcnt(0)
    v_add_f32 v20, v20, v28
    v_add_f32 v21, v21, v29
    v_add_f32 v22, v22, v30
    v_add_f32 v23, v23, v31
    v_add_f32 v0, v0, v16
    v_add_f32 v1, v1, v17
    v_add_f32 v2, v2, v18
    v_add_f32 v3, v3, v19
    v_add_f32 v4, v4, v20
    v_add_f32 v5, v5, v21
    v_add_f32 v6, v6, v22
    v_add_f32 v7, v7, v23
    v_cvt_pk_bf16_f32 v32, v0, v1
    v_cvt_pk_bf16_f32 v33, v2, v3
    v_cvt_pk_bf16_f32 v34, v4, v5
    v_cvt_pk_bf16_f32 v35, v6, v7
    buffer_store_dwordx4 v[32:35], v232, s[32:35], s88 offen sc1
L_end:
    s_endpgm
.fill ((37120 - (. - gated_mix__linear_kernel_hedgehog__glu_gated_bilinear__prompt_kernel)) / 4), 4, 0xbf810000
.section .rodata,"a"
.p2align 6
.amdhsa_kernel gated_mix__linear_kernel_hedgehog__glu_gated_bilinear__prompt_kernel
  .amdhsa_next_free_vgpr 256
  .amdhsa_next_free_sgpr 102
  .amdhsa_accum_offset 256
  .amdhsa_group_segment_fixed_size 0
  .amdhsa_kernarg_size 96
  .amdhsa_user_sgpr_count 2
  .amdhsa_user_sgpr_kernarg_segment_ptr 1
  .amdhsa_system_sgpr_workgroup_id_x 1
.end_amdhsa_kernel
```
